```python
import torch

def _softmax(x, axis=-1):
    return torch.softmax(x, dim=axis)

def _gelu(x):
    return torch.nn.functional.gelu(x, approximate='tanh')

def _silu(x):
    return torch.nn.functional.silu(x)

def _sigmoid(x):
    return torch.sigmoid(x)

def _layernorm(x, axis=-1, eps=1e-05):
    m = x.mean(dim=axis, keepdim=True)
    v = x.var(dim=axis, keepdim=True, unbiased=False)
    return (x - m) / torch.sqrt(v + eps)

def _scatter_add(tgt, idx, src, axis=0):
    return tgt.clone().index_add_(axis, idx, src)

def _segment_sum(src, seg, n):
    out = torch.zeros((n,) + src.shape[1:], dtype=src.dtype)
    return out.index_add_(0, seg, src)

def _pad(x, pw):
    flat = tuple((v for pair in reversed(pw) for v in pair))
    return torch.nn.functional.pad(x, flat)
kernel_name = 'adaLN_cond__gqa_block_cached__dense_activation_relu__decode'

def setup_inputs():

    _w = lambda a: (lambda t: t.to(torch.bfloat16) if t.is_floating_point() else t)(torch.as_tensor(a))

    def _A_setup():
        B, Sq, D = (4, 1, 448)
        Hq, Hkv, Sk, Dh = (16, 8, 4096, 256)
        assert Hq % Hkv == 0, (Hq, Hkv)
        return {'x': _w((lambda *s: torch.randn(*s, dtype=torch.bfloat16) * 0.05)(B, Sq, D)), 'k_cache': _w((lambda *s: torch.randn(*s, dtype=torch.bfloat16) * 3.2)(B, Hkv, Sk, Dh)), 'v_cache': _w((lambda *s: torch.randn(*s, dtype=torch.bfloat16) * 0.4)(B, Hkv, Sk, Dh)), 'wq': _w((lambda *s: torch.randn(*s, dtype=torch.bfloat16) * 3.2)(D, Hq * Dh) * D ** (-0.5)), 'wo': _w((lambda *s: torch.randn(*s, dtype=torch.bfloat16) * 0.4)(Hq * Dh, D) * (Hq * Dh) ** (-0.5))}
    _A_in = _A_setup()

    def _B_setup():
        B, S, D, Dff = (4, 1, 448, 1792)
        return {'x': _w((lambda *s: torch.randn(*s, dtype=torch.bfloat16) * 0.05)(B, S, D)), 'w1': _w((lambda *s: torch.randn(*s, dtype=torch.bfloat16) * 0.05)(D, Dff)), 'w2': _w((lambda *s: torch.randn(*s, dtype=torch.bfloat16) * 0.05)(Dff, D))}
    _B_in = _B_setup()
    return {'A_x': _A_in['x'], 'A_k_cache': _A_in['k_cache'], 'A_v_cache': _A_in['v_cache'], 'A_wq': _A_in['wq'], 'A_wo': _A_in['wo'], 'B_x': _B_in['x'], 'B_w1': _B_in['w1'], 'B_w2': _B_in['w2'], 'c': _w((lambda *s: torch.randn(*s, dtype=torch.bfloat16) * 0.2)(4, 448) * 8.0), 'w_mod': _w((lambda *s: torch.randn(*s, dtype=torch.bfloat16) * 0.2)(448, 6 * 448) * 448 ** (-0.5) * 8.0)}

def reference(A_x, A_k_cache, A_v_cache, A_wq, A_wo, B_x, B_w1, B_w2, c, w_mod):

    def _A_ref(x, k_cache, v_cache, wq, wo):
        B, Sq, D = x.shape
        Hq, Dh = (16, 256)
        Hkv = k_cache.shape[1]
        rep = Hq // Hkv
        q = (lambda x, *d: x.permute(*d))((x @ wq).reshape(B, Sq, Hq, Dh), 0, 2, 1, 3)
        k = (lambda x, n, axis: torch.repeat_interleave(x, n, dim=axis))(k_cache, rep, axis=1)
        v = (lambda x, n, axis: torch.repeat_interleave(x, n, dim=axis))(v_cache, rep, axis=1)
        scores = torch.einsum('bhqd,bhkd->bhqk', q, k) * Dh ** (-0.5)
        p = _softmax(scores, axis=-1)
        o = torch.einsum('bhqk,bhkd->bhqd', p, v)
        return (lambda x, *d: x.permute(*d))(o, 0, 2, 1, 3).reshape(B, Sq, Hq * Dh) @ wo

    def _B_ref(x, w1, w2):
        h = torch.einsum('bsd,df->bsf', x, w1)
        zero = torch.zeros_like(h)
        h = torch.maximum(h, zero)
        return torch.einsum('bsf,fd->bsd', h, w2)
    x = A_x
    mod = (_silu(c) @ w_mod).reshape(c.shape[0], 6, 1, -1)
    sa, ca, ga, sb, cb, gb = (mod[:, 0].clone(), mod[:, 1].clone(), mod[:, 2].clone(), mod[:, 3].clone(), mod[:, 4].clone(), mod[:, 5].clone())
    h = _layernorm(x, axis=-1) * (1 + ca) + sa
    x = x + ga * _A_ref(h, A_k_cache, A_v_cache, A_wq, A_wo)
    h = _layernorm(x, axis=-1) * (1 + cb) + sb
    x = x + gb * _B_ref(h, B_w1, B_w2)
    return x
```

```asm
; @launch grid=(256,1,1) block=(512,1,1) lds=160768
.amdgcn_target "amdgcn-amd-amdhsa--gfx950"
.text
.globl adaLN_cond__gqa_block_cached__dense_activation_relu__decode_kernel
.p2align 8
.type adaLN_cond__gqa_block_cached__dense_activation_relu__decode_kernel,@function
adaLN_cond__gqa_block_cached__dense_activation_relu__decode_kernel:
s_cmp_ge_u32 s2, 256
s_cbranch_scc1 L_end
s_load_dwordx16 s[16:31], s[0:1], 0
s_load_dwordx8 s[32:39], s[0:1], 64
s_load_dwordx2 s[40:41], s[0:1], 96
v_lshrrev_b32 v1, 6, v0
v_and_b32 v0, 63, v0
v_readfirstlane_b32 s3, v1
s_and_b32 s4, s2, 7
s_lshr_b32 s5, s2, 3
s_and_b32 s6, s5, 3
s_lshr_b32 s7, s5, 2
s_lshl_b32 s12, s4, 2
s_lshr_b32 s98, 0x43358883, s12
s_and_b32 s98, s98, 15
v_lshrrev_b32 v3, 4, v0
v_lshlrev_b32 v3, 7, v3
v_bfe_u32 v4, v0, 3, 1
v_lshl_add_u32 v3, v4, 9, v3
v_and_b32 v4, 7, v0
v_lshl_add_u32 v1, v4, 4, v3
v_lshlrev_b32 v2, 4, v0
s_cmp_eq_u32 s3, 7
s_cbranch_scc1 L_svpro
s_lshl3_add_u32 s11, s6, s4
s_lshl3_add_u32 s11, s11, s7
s_lshl_b32 s11, s11, 8
s_mov_b32 s14, 0xf8f5f200
s_mov_b32 s15, 0x401fefb
s_add_u32 s99, s6, 4
s_cmp_lt_u32 s99, s98
s_cselect_b32 s14, 0xf1eef500, s14
s_cselect_b32 s15, 0xfdfaf7f4, s15
s_cselect_b32 s99, s6, 0
s_cmp_eq_u32 s99, 1
s_cselect_b32 s14, 0xf4f1f500, s14
s_cselect_b32 s15, 0xfdfaf7, s15
s_cmp_ge_u32 s6, s98
s_cselect_b32 s14, 0x2060300, s14
s_cselect_b32 s15, 0x40401fe, s15
s_lshl_b32 s99, s7, 3
s_lshr_b64 s[14:15], s[14:15], s99
s_sext_i32_i8 s12, s14
s_bfe_i32 s13, s14, 0x80008
s_add_u32 s11, s11, s12
s_lshl_b32 s11, s11, 10
s_sub_u32 s13, s13, s12
s_add_u32 s13, s13, 256
s_lshl_b32 s46, s13, 10
s_mov_b32 s47, 0x20000
s_lshl_b32 s8, s3, 10
s_cmp_lt_u32 s5, s98
s_cselect_b32 s12, 255, s2
s_cmp_lt_u32 s12, 224
s_cselect_b64 vcc, 0, -1
s_cbranch_vccnz L_role
s_waitcnt lgkmcnt(0)
s_add_u32 s44, s18, s11
s_addc_u32 s45, s19, 0
s_and_b32 s45, s45, 0xffff
buffer_load_dwordx4 v[8:11], v1, s[44:47], s8 offen nt
s_add_u32 s8, s8, 7168
buffer_load_dwordx4 v[12:15], v1, s[44:47], s8 offen nt
s_add_u32 s8, s8, 7168
buffer_load_dwordx4 v[16:19], v1, s[44:47], s8 offen nt
s_add_u32 s8, s8, 7168
buffer_load_dwordx4 v[20:23], v1, s[44:47], s8 offen nt
s_barrier
s_branch L_eb
L_svpro:
s_setprio 3
v_mov_b32 v4, -1
v_mov_b32 v5, -1
v_mov_b32 v6, -1
v_mov_b32 v7, -1
v_add_u32 v19, 155136, v2
ds_write_b128 v19, v[4:7]
s_mov_b32 exec_lo, 0xf
s_mov_b32 exec_hi, 0
ds_write_b128 v19, v[4:7] offset:1024
s_mov_b64 exec, -1
v_and_b32 v8, 3, v0
v_lshrrev_b32 v9, 2, v0
v_mul_u32_u24 v10, 896, v8
v_lshl_add_u32 v10, v9, 4, v10
s_mov_b32 s14, 0x2010018
s_mov_b32 s15, 0x2623201b
s_lshl_b32 s12, s4, 3
s_lshr_b64 s[14:15], s[14:15], s12
s_and_b32 s14, s14, 0xff
s_cmp_eq_u32 s98, 8
s_cselect_b32 s12, 3, 1
s_mul_i32 s12, s12, s5
s_add_u32 s12, s12, s14
s_cmp_lt_u32 s5, s98
s_cselect_b32 s5, s12, 63
s_mov_b32 s66, 200000
s_lshl2_add_u32 s9, s4, s6
s_mul_i32 s10, s4, 7
s_add_u32 s10, s10, s7
s_cmp_ge_u32 s2, 224
s_cselect_b32 s12, 0, s5
s_cmp_ge_u32 s12, 42
s_waitcnt lgkmcnt(0)
s_cbranch_scc1 L_sv1
s_cmp_lt_u32 s5, 42
s_cselect_b32 s44, s32, s16
s_cselect_b32 s45, s33, s17
s_and_b32 s45, s45, 0xffff
s_mov_b32 s46, 3584
s_mov_b32 s47, 0x20000
buffer_load_dwordx4 v[48:51], v10, s[44:47], 0 offen offset:0
buffer_load_dwordx4 v[52:55], v10, s[44:47], 0 offen offset:256
buffer_load_dwordx4 v[56:59], v10, s[44:47], 0 offen offset:512
buffer_load_dwordx4 v[60:63], v10, s[44:47], 0 offen offset:768
s_branch L_sv0
L_sv1:
s_cmp_eq_u32 s2, 162
s_cbranch_scc0 L_sv0
v_add_u32 v20, 4096, v2
v_add_u32 v19, 8192, v2
global_store_dwordx4 v2, v[4:7], s[40:41] offset:0 sc1
global_store_dwordx4 v2, v[4:7], s[40:41] offset:1024 sc1
global_store_dwordx4 v2, v[4:7], s[40:41] offset:2048 sc1
global_store_dwordx4 v2, v[4:7], s[40:41] offset:3072 sc1
global_store_dwordx4 v20, v[4:7], s[40:41] offset:0 sc1
global_store_dwordx4 v20, v[4:7], s[40:41] offset:1024 sc1
global_store_dwordx4 v20, v[4:7], s[40:41] offset:2048 sc1
global_store_dwordx4 v20, v[4:7], s[40:41] offset:3072 sc1
global_store_dwordx4 v19, v[4:7], s[40:41] offset:0 sc1
global_store_dwordx4 v19, v[4:7], s[40:41] offset:1024 sc1
global_store_dwordx4 v19, v[4:7], s[40:41] offset:2048 sc1
L_sv0:
s_barrier
s_branch L_service
L_stream:
L_role:
s_cmp_ge_u32 s2, 224
s_cbranch_scc1 L_slice_q
s_mov_b32 s14, 0x2010018
s_mov_b32 s15, 0x2623201b
s_lshl_b32 s12, s4, 3
s_lshr_b64 s[14:15], s[14:15], s12
s_and_b32 s14, s14, 0xff
s_cmp_eq_u32 s98, 8
s_cselect_b32 s12, 3, 1
s_mul_i32 s12, s12, s5
s_add_u32 s5, s12, s14
s_lshl_b32 s67, s5, 7
v_lshrrev_b32 v253, 3, v0
v_mul_u32_u24 v248, 5376, v253
v_and_b32 v253, 2, v253
v_and_b32 v252, 7, v0
v_xor_b32 v253, v253, v252
v_xor_b32 v252, 4, v253
v_lshl_add_u32 v253, v253, 4, v248
v_lshl_add_u32 v252, v252, 4, v248
s_lshl_b32 s15, s3, 13
s_add_u32 s15, s15, 94208
s_mov_b32 s13, 43008
s_mul_i32 s12, s3, 344064
s_mov_b32 s54, 2403200
s_mov_b32 s55, 0x20000
s_mov_b32 s68, 1
s_waitcnt lgkmcnt(0)
s_add_u32 s52, s34, s67
s_addc_u32 s53, s35, 0
s_and_b32 s53, s53, 0xffff
s_branch L_slice_half
L_slice_q:
s_lshl2_add_u32 s67, s4, s6
s_lshl_b32 s67, s67, 8
v_lshrrev_b32 v253, 3, v0
v_mul_u32_u24 v248, 8192, v253
v_and_b32 v253, 2, v253
v_and_b32 v252, 7, v0
v_xor_b32 v253, v253, v252
v_xor_b32 v252, 4, v253
v_lshl_add_u32 v253, v253, 4, v248
v_lshl_add_u32 v252, v252, 4, v248
s_lshl_b32 s15, s3, 13
s_mov_b32 s13, 65536
s_mul_i32 s12, s3, 524288
s_mov_b32 s54, 3662080
s_mov_b32 s55, 0x20000
s_mov_b32 s68, 1
s_waitcnt lgkmcnt(0)
s_add_u32 s52, s22, s67
s_addc_u32 s53, s23, 0
s_and_b32 s53, s53, 0xffff
L_slice_half:
s_mov_b32 m0, s15
s_mov_b32 s69, s12
s_waitcnt vmcnt(4)
buffer_load_dwordx4 v253, s[52:55], s69 offen nt lds
s_add_u32 m0, m0, 1024
s_add_u32 s69, s69, s13
s_waitcnt vmcnt(4)
buffer_load_dwordx4 v252, s[52:55], s69 offen nt lds
s_add_u32 m0, m0, 1024
s_add_u32 s69, s69, s13
s_waitcnt vmcnt(4)
buffer_load_dwordx4 v253, s[52:55], s69 offen nt lds
s_add_u32 m0, m0, 1024
s_add_u32 s69, s69, s13
s_waitcnt vmcnt(4)
buffer_load_dwordx4 v252, s[52:55], s69 offen nt lds
s_add_u32 m0, m0, 1024
s_add_u32 s69, s69, s13
s_waitcnt vmcnt(4)
buffer_load_dwordx4 v253, s[52:55], s69 offen nt lds
s_add_u32 m0, m0, 1024
s_add_u32 s69, s69, s13
s_cmp_eq_u32 s68, 1
s_cbranch_scc0 L_sl_nb
s_barrier
s_mov_b32 s68, 0
L_sl_nb:
s_waitcnt vmcnt(4)
buffer_load_dwordx4 v252, s[52:55], s69 offen nt lds
s_add_u32 m0, m0, 1024
s_add_u32 s69, s69, s13
s_waitcnt vmcnt(4)
buffer_load_dwordx4 v253, s[52:55], s69 offen nt lds
s_add_u32 m0, m0, 1024
s_add_u32 s69, s69, s13
s_waitcnt vmcnt(4)
buffer_load_dwordx4 v252, s[52:55], s69 offen nt lds
s_cmp_lt_u32 s15, 57344
s_cbranch_scc0 L_slice_done
s_add_u32 s15, s15, 57344
s_add_u32 s12, s12, 128
s_branch L_slice_half
L_slice_done:
s_add_u32 s44, s18, s11
s_addc_u32 s45, s19, 0
s_and_b32 s45, s45, 0xffff
s_cbranch_vccnz L_th1
s_waitcnt vmcnt(3)
L_th1:
s_waitcnt vmcnt(4)
buffer_load_dwordx4 v[8:11], v1, s[44:47], s8 offen nt
s_cbranch_vccnz L_th2
s_waitcnt vmcnt(3)
L_th2:
s_waitcnt vmcnt(4)
s_add_u32 s8, s8, 7168
buffer_load_dwordx4 v[12:15], v1, s[44:47], s8 offen nt
s_cbranch_vccnz L_th3
s_waitcnt vmcnt(3)
L_th3:
s_waitcnt vmcnt(4)
s_add_u32 s8, s8, 7168
buffer_load_dwordx4 v[16:19], v1, s[44:47], s8 offen nt
s_cbranch_vccnz L_th4
s_waitcnt vmcnt(3)
L_th4:
s_waitcnt vmcnt(4)
s_add_u32 s8, s8, 7168
buffer_load_dwordx4 v[20:23], v1, s[44:47], s8 offen nt
L_eb:
s_mov_b64 s[96:97], vcc
s_mov_b32 s66, 200000
s_lshl2_add_u32 s9, s4, s6
s_mul_i32 s10, s4, 7
s_add_u32 s10, s10, s7
s_add_u32 s48, s20, s11
s_addc_u32 s49, s21, 0
s_and_b32 s49, s49, 0xffff
s_mov_b32 s50, s46
s_mov_b32 s51, 0x20000
s_lshl_b32 s65, s3, 10
v_and_b32 v4, 1, v0
v_mov_b32 v5, 0xffff
v_lshlrev_b32 v4, 4, v4
v_lshlrev_b32 v5, v4, v5
v_bfe_u32 v4, v0, 1, 3
v_cmp_eq_u32 vcc, 0, v4
s_nop 1
v_cndmask_b32 v208, 0, v5, vcc
v_cmp_eq_u32 vcc, 1, v4
s_nop 1
v_cndmask_b32 v209, 0, v5, vcc
v_cmp_eq_u32 vcc, 2, v4
s_nop 1
v_cndmask_b32 v210, 0, v5, vcc
v_cmp_eq_u32 vcc, 3, v4
s_nop 1
v_cndmask_b32 v211, 0, v5, vcc
s_mov_b32 s70, 0x11111111
s_mov_b32 s71, 0x11111111
s_mov_b32 s72, 0x22222222
s_mov_b32 s73, 0x22222222
s_mov_b32 s74, 0x44444444
s_mov_b32 s75, 0x44444444
s_mov_b32 s76, 0x88888888
s_mov_b32 s77, 0x88888888
v_and_b32 v4, 3, v0
v_lshlrev_b32 v4, 2, v4
v_bfe_u32 v5, v0, 2, 1
v_lshl_or_b32 v4, v5, 1, v4
v_bfe_u32 v5, v0, 3, 1
v_or_b32 v4, v5, v4
v_mul_u32_u24 v4, 7, v4
s_lshr_b32 s12, s46, 10
s_sub_u32 s12, s12, 224
s_sub_u32 s12, s12, s3
v_cmp_le_i32 s[78:79], s12, v4
v_mov_b32 v214, 0xff800000
v_and_b32 v215, 0x27, v0
v_lshrrev_b32 v4, 1, v0
v_and_b32 v4, 8, v4
v_or_b32 v215, v215, v4
v_lshlrev_b32 v4, 1, v0
v_and_b32 v4, 16, v4
v_or_b32 v215, v215, v4
v_lshlrev_b32 v215, 2, v215
s_lshl_b32 s12, s9, 10
s_lshl_b32 s13, s7, 7
s_add_u32 s12, s12, s13
s_lshl_b32 s13, s3, 4
s_add_u32 s12, s12, s13
s_add_u32 s12, s12, 98304
v_bfe_u32 v4, v0, 4, 1
v_lshlrev_b32 v4, 3, v4
v_add_u32 v3, s12, v4
v_add_u32 v5, 156160, v4
v_add_u32 v6, 155136, v2
s_lshl_b32 s12, s3, 2
s_add_u32 s12, s12, 156192
v_mov_b32 v7, s12
s_cmp_lt_u32 s7, 7
s_cselect_b32 s67, 57344, 0
s_cselect_b32 s68, 225856, 0
s_lshl_b32 s12, s4, 9
s_lshl_b32 s13, s3, 6
s_add_u32 s12, s12, s13
s_mul_i32 s12, s12, 896
s_lshl_b32 s13, s7, 7
s_add_u32 s12, s12, s13
s_add_u32 s52, s24, s12
s_addc_u32 s53, s25, 0
s_and_b32 s53, s53, 0xffff
s_mov_b32 s54, s67
s_mov_b32 s55, 0x20000
s_mul_i32 s12, s3, 229376
s_lshl_b32 s13, s10, 6
s_add_u32 s12, s12, s13
s_add_u32 s56, s28, s12
s_addc_u32 s57, s29, 0
s_and_b32 s57, s57, 0xffff
s_mov_b32 s58, s68
s_mov_b32 s59, 0x20000
s_mul_i32 s12, s10, 28672
s_lshl_b32 s13, s3, 7
s_add_u32 s12, s12, s13
s_cmp_lt_u32 s7, 7
s_cselect_b32 s67, 27904, 0
s_add_u32 s60, s30, s12
s_addc_u32 s61, s31, 0
s_and_b32 s61, s61, 0xffff
s_mov_b32 s62, s67
s_mov_b32 s63, 0x20000
s_lshl_b32 s42, s3, 13
s_lshl_b32 s12, s3, 12
s_add_u32 s43, s12, 65536
s_add_u32 s64, s12, 94208
s_cmp_lt_u32 s7, 7
s_cselect_b32 s42, s42, 114688
s_cselect_b32 s43, s43, 114688
s_cselect_b32 s64, s64, 114688
v_lshrrev_b32 v253, 3, v0
v_mul_u32_u24 v248, 896, v253
v_and_b32 v253, 2, v253
v_and_b32 v252, 7, v0
v_xor_b32 v253, v253, v252
v_xor_b32 v252, 4, v253
v_lshl_add_u32 v253, v253, 4, v248
v_lshl_add_u32 v252, v252, 4, v248
v_lshrrev_b32 v254, 2, v0
v_mul_u32_u24 v254, 3584, v254
v_lshrrev_b32 v248, 4, v0
v_and_b32 v248, 2, v248
v_and_b32 v249, 3, v0
v_xor_b32 v248, v248, v249
v_lshl_add_u32 v254, v248, 4, v254
s_mov_b64 vcc, s[96:97]
s_cbranch_vccnz L_th5
s_waitcnt vmcnt(3)
L_th5:
s_waitcnt vmcnt(4)
s_waitcnt vmcnt(4)
s_mov_b32 exec_lo, 1
s_mov_b32 exec_hi, 0
ds_write_b32 v7, v7
s_mov_b64 exec, -1
s_add_u32 s8, s8, 7168
buffer_load_dwordx4 v[24:27], v1, s[44:47], s8 offen nt
s_cbranch_vccnz L_th6
s_waitcnt vmcnt(3)
L_th6:
s_waitcnt vmcnt(4)
s_add_u32 s8, s8, 7168
buffer_load_dwordx4 v[28:31], v1, s[44:47], s8 offen nt
s_cbranch_vccnz L_th7
s_waitcnt vmcnt(3)
L_th7:
s_waitcnt vmcnt(4)
s_add_u32 s8, s8, 7168
buffer_load_dwordx4 v[32:35], v1, s[44:47], s8 offen nt
s_cbranch_vccnz L_th8
s_waitcnt vmcnt(3)
L_th8:
s_waitcnt vmcnt(4)
s_add_u32 s8, s8, 7168
buffer_load_dwordx4 v[36:39], v1, s[44:47], s8 offen nt
s_cbranch_vccnz L_th9
s_waitcnt vmcnt(3)
L_th9:
s_waitcnt vmcnt(4)
s_add_u32 s8, s8, 7168
buffer_load_dwordx4 v[40:43], v1, s[44:47], s8 offen nt
s_cbranch_vccnz L_th10
s_waitcnt vmcnt(3)
L_th10:
s_waitcnt vmcnt(4)
s_add_u32 m0, s42, 0
s_mov_b32 s69, 0
buffer_load_dwordx4 v253, s[52:55], s69 offen nt lds
s_cbranch_vccnz L_th11
s_waitcnt vmcnt(3)
L_th11:
s_waitcnt vmcnt(4)
s_add_u32 s8, s8, 7168
buffer_load_dwordx4 v[44:47], v1, s[44:47], s8 offen nt
s_cbranch_vccnz L_th12
s_waitcnt vmcnt(3)
L_th12:
s_waitcnt vmcnt(4)
s_add_u32 s8, s8, 7168
buffer_load_dwordx4 v[48:51], v1, s[44:47], s8 offen nt
s_cbranch_vccnz L_th13
s_waitcnt vmcnt(3)
L_th13:
s_waitcnt vmcnt(4)
s_add_u32 s8, s8, 7168
buffer_load_dwordx4 v[52:55], v1, s[44:47], s8 offen nt
s_cbranch_vccnz L_th14
s_waitcnt vmcnt(3)
L_th14:
s_waitcnt vmcnt(4)
s_add_u32 m0, s42, 1024
s_mov_b32 s69, 7168
buffer_load_dwordx4 v252, s[52:55], s69 offen nt lds
s_cbranch_vccnz L_th15
s_waitcnt vmcnt(3)
L_th15:
s_waitcnt vmcnt(4)
s_add_u32 s8, s8, 7168
buffer_load_dwordx4 v[56:59], v1, s[44:47], s8 offen nt
s_cbranch_vccnz L_th16
s_waitcnt vmcnt(3)
L_th16:
s_waitcnt vmcnt(4)
s_add_u32 s8, s8, 7168
buffer_load_dwordx4 v[60:63], v1, s[44:47], s8 offen nt
s_cbranch_vccnz L_th17
s_waitcnt vmcnt(3)
L_th17:
s_waitcnt vmcnt(4)
s_add_u32 s8, s8, 7168
buffer_load_dwordx4 v[64:67], v1, s[44:47], s8 offen nt
s_cbranch_vccnz L_th18
s_waitcnt vmcnt(3)
L_th18:
s_waitcnt vmcnt(4)
s_add_u32 s8, s8, 7168
buffer_load_dwordx4 v[68:71], v1, s[44:47], s8 offen nt
s_cbranch_vccnz L_th19
s_waitcnt vmcnt(3)
L_th19:
s_waitcnt vmcnt(4)
s_add_u32 m0, s42, 2048
s_mov_b32 s69, 14336
buffer_load_dwordx4 v253, s[52:55], s69 offen nt lds
s_cbranch_vccnz L_th20
s_waitcnt vmcnt(3)
L_th20:
s_waitcnt vmcnt(4)
s_add_u32 s8, s8, 7168
buffer_load_dwordx4 v[72:75], v1, s[44:47], s8 offen nt
s_cbranch_vccnz L_th21
s_waitcnt vmcnt(3)
L_th21:
s_waitcnt vmcnt(4)
s_add_u32 s8, s8, 7168
buffer_load_dwordx4 v[76:79], v1, s[44:47], s8 offen nt
s_cbranch_vccnz L_th22
s_waitcnt vmcnt(3)
L_th22:
s_waitcnt vmcnt(4)
s_add_u32 s8, s8, 7168
buffer_load_dwordx4 v[80:83], v1, s[44:47], s8 offen nt
s_cbranch_vccnz L_th23
s_waitcnt vmcnt(3)
L_th23:
s_waitcnt vmcnt(4)
s_add_u32 m0, s42, 3072
s_mov_b32 s69, 21504
buffer_load_dwordx4 v252, s[52:55], s69 offen nt lds
s_cbranch_vccnz L_th24
s_waitcnt vmcnt(3)
L_th24:
s_waitcnt vmcnt(4)
s_add_u32 s8, s8, 7168
buffer_load_dwordx4 v[84:87], v1, s[44:47], s8 offen nt
s_cbranch_vccnz L_th25
s_waitcnt vmcnt(3)
L_th25:
s_waitcnt vmcnt(4)
s_add_u32 s8, s8, 7168
buffer_load_dwordx4 v[88:91], v1, s[44:47], s8 offen nt
s_cbranch_vccnz L_th26
s_waitcnt vmcnt(3)
L_th26:
s_waitcnt vmcnt(4)
s_add_u32 s8, s8, 7168
buffer_load_dwordx4 v[92:95], v1, s[44:47], s8 offen nt
s_cbranch_vccnz L_th27
s_waitcnt vmcnt(3)
L_th27:
s_waitcnt vmcnt(4)
s_add_u32 s8, s8, 7168
buffer_load_dwordx4 v[96:99], v1, s[44:47], s8 offen nt
s_cbranch_vccnz L_th28
s_waitcnt vmcnt(3)
L_th28:
s_waitcnt vmcnt(4)
s_add_u32 m0, s42, 4096
s_mov_b32 s69, 28672
buffer_load_dwordx4 v253, s[52:55], s69 offen nt lds
s_cbranch_vccnz L_th29
s_waitcnt vmcnt(3)
L_th29:
s_waitcnt vmcnt(4)
s_add_u32 s8, s8, 7168
buffer_load_dwordx4 v[100:103], v1, s[44:47], s8 offen nt
s_cbranch_vccnz L_th30
s_waitcnt vmcnt(3)
L_th30:
s_add_u32 s8, s8, 7168
buffer_load_dwordx4 v[104:107], v1, s[44:47], s8 offen nt
s_cbranch_vccnz L_th31
s_waitcnt vmcnt(3)
L_th31:
s_waitcnt vmcnt(5)
s_add_u32 s8, s8, 7168
buffer_load_dwordx4 v[108:111], v1, s[44:47], s8 offen nt
s_cbranch_vccnz L_th32
s_waitcnt vmcnt(3)
L_th32:
s_waitcnt vmcnt(5)
s_add_u32 m0, s42, 5120
s_mov_b32 s69, 35840
buffer_load_dwordx4 v252, s[52:55], s69 offen nt lds
s_cbranch_vccnz L_th33
s_waitcnt vmcnt(3)
L_th33:
s_waitcnt vmcnt(5)
s_add_u32 s8, s8, 7168
buffer_load_dwordx4 v[112:115], v1, s[44:47], s8 offen nt
s_cbranch_vccnz L_th34
s_waitcnt vmcnt(3)
L_th34:
s_waitcnt vmcnt(5)
s_add_u32 s8, s8, 7168
buffer_load_dwordx4 v[116:119], v1, s[44:47], s8 offen nt
s_cbranch_vccnz L_th35
s_waitcnt vmcnt(3)
L_th35:
s_waitcnt vmcnt(5)
s_add_u32 s8, s8, 7168
buffer_load_dwordx4 v[120:123], v1, s[44:47], s8 offen nt
s_cbranch_vccnz L_th36
s_waitcnt vmcnt(3)
L_th36:
s_waitcnt vmcnt(5)
s_add_u32 s8, s8, 7168
buffer_load_dwordx4 v[124:127], v1, s[44:47], s8 offen nt
s_cbranch_vccnz L_th37
s_waitcnt vmcnt(3)
L_th37:
s_waitcnt vmcnt(5)
s_add_u32 m0, s42, 6144
s_mov_b32 s69, 43008
buffer_load_dwordx4 v253, s[52:55], s69 offen nt lds
s_cbranch_vccnz L_th38
s_waitcnt vmcnt(3)
L_th38:
s_waitcnt vmcnt(5)
s_add_u32 s8, s8, 7168
buffer_load_dwordx4 v[128:131], v1, s[44:47], s8 offen nt
s_cbranch_vccnz L_th39
s_waitcnt vmcnt(3)
L_th39:
s_waitcnt vmcnt(5)
s_add_u32 s8, s8, 7168
buffer_load_dwordx4 v[132:135], v1, s[44:47], s8 offen nt
s_cbranch_vccnz L_th40
s_waitcnt vmcnt(3)
L_th40:
s_waitcnt vmcnt(5)
s_add_u32 s8, s8, 7168
buffer_load_dwordx4 v[136:139], v1, s[44:47], s8 offen nt
s_cbranch_vccnz L_th41
s_waitcnt vmcnt(3)
L_th41:
s_waitcnt vmcnt(5)
s_add_u32 m0, s42, 7168
s_mov_b32 s69, 50176
buffer_load_dwordx4 v252, s[52:55], s69 offen nt lds
s_cbranch_vccnz L_th42
s_waitcnt vmcnt(3)
L_th42:
s_waitcnt vmcnt(5)
s_add_u32 s8, s8, 7168
buffer_load_dwordx4 v[140:143], v1, s[44:47], s8 offen nt
s_cbranch_vccnz L_th43
s_waitcnt vmcnt(3)
L_th43:
s_waitcnt vmcnt(5)
s_add_u32 s8, s8, 7168
buffer_load_dwordx4 v[144:147], v1, s[44:47], s8 offen nt
s_cbranch_vccnz L_th44
s_waitcnt vmcnt(3)
L_th44:
s_waitcnt vmcnt(5)
s_add_u32 s8, s8, 7168
buffer_load_dwordx4 v[148:151], v1, s[44:47], s8 offen nt
s_cbranch_vccnz L_th45
s_waitcnt vmcnt(3)
L_th45:
s_waitcnt vmcnt(5)
s_add_u32 s8, s8, 7168
buffer_load_dwordx4 v[152:155], v1, s[44:47], s8 offen nt
s_cbranch_vccnz L_th46
s_waitcnt vmcnt(3)
L_th46:
s_waitcnt vmcnt(5)
s_add_u32 m0, s43, 0
s_mov_b32 s69, 0
buffer_load_dwordx4 v254, s[56:59], s69 offen nt lds
s_cbranch_vccnz L_th47
s_waitcnt vmcnt(3)
L_th47:
s_waitcnt vmcnt(5)
s_add_u32 s69, s65, 0
buffer_load_dwordx4 v[156:159], v2, s[48:51], s69 offen nt
s_cbranch_vccnz L_th48
s_waitcnt vmcnt(3)
L_th48:
s_waitcnt vmcnt(5)
s_add_u32 s69, s65, 7168
buffer_load_dwordx4 v[160:163], v2, s[48:51], s69 offen nt
s_cbranch_vccnz L_th49
s_waitcnt vmcnt(3)
L_th49:
s_waitcnt vmcnt(5)
s_add_u32 s69, s65, 14336
buffer_load_dwordx4 v[164:167], v2, s[48:51], s69 offen nt
s_mov_b32 s67, 3
ds_read_b128 v[204:207], v6
s_waitcnt lgkmcnt(0)
v_max3_u32 v248, v204, v205, v206
v_max_u32 v248, v248, v207
v_cmp_eq_u32 s[98:99], -1, v248
s_cmp_eq_u64 s[98:99], 0
s_cbranch_scc1 L_qk
s_cbranch_vccnz L_th50
s_waitcnt vmcnt(3)
L_th50:
s_waitcnt vmcnt(5)
s_add_u32 m0, s43, 1024
s_mov_b32 s69, 57344
buffer_load_dwordx4 v254, s[56:59], s69 offen nt lds
s_mov_b32 s67, 4
ds_read_b128 v[204:207], v6
s_waitcnt lgkmcnt(0)
v_max3_u32 v248, v204, v205, v206
v_max_u32 v248, v248, v207
v_cmp_eq_u32 s[98:99], -1, v248
s_cmp_eq_u64 s[98:99], 0
s_cbranch_scc1 L_qk
s_cbranch_vccnz L_th51
s_waitcnt vmcnt(3)
L_th51:
s_waitcnt vmcnt(5)
s_add_u32 s69, s65, 21504
buffer_load_dwordx4 v[168:171], v2, s[48:51], s69 offen nt
s_mov_b32 s67, 5
ds_read_b128 v[204:207], v6
s_waitcnt lgkmcnt(0)
v_max3_u32 v248, v204, v205, v206
v_max_u32 v248, v248, v207
v_cmp_eq_u32 s[98:99], -1, v248
s_cmp_eq_u64 s[98:99], 0
s_cbranch_scc1 L_qk
s_cbranch_vccnz L_th52
s_waitcnt vmcnt(3)
L_th52:
s_waitcnt vmcnt(5)
s_add_u32 m0, s43, 2048
s_mov_b32 s69, 114688
buffer_load_dwordx4 v254, s[56:59], s69 offen nt lds
s_mov_b32 s67, 6
ds_read_b128 v[204:207], v6
s_waitcnt lgkmcnt(0)
v_max3_u32 v248, v204, v205, v206
v_max_u32 v248, v248, v207
v_cmp_eq_u32 s[98:99], -1, v248
s_cmp_eq_u64 s[98:99], 0
s_cbranch_scc1 L_qk
s_cbranch_vccnz L_th53
s_waitcnt vmcnt(3)
L_th53:
s_waitcnt vmcnt(5)
s_add_u32 s69, s65, 28672
buffer_load_dwordx4 v[172:175], v2, s[48:51], s69 offen nt
s_mov_b32 s67, 7
ds_read_b128 v[204:207], v6
s_waitcnt lgkmcnt(0)
v_max3_u32 v248, v204, v205, v206
v_max_u32 v248, v248, v207
v_cmp_eq_u32 s[98:99], -1, v248
s_cmp_eq_u64 s[98:99], 0
s_cbranch_scc1 L_qk
s_cbranch_vccnz L_th54
s_waitcnt vmcnt(3)
L_th54:
s_waitcnt vmcnt(5)
s_add_u32 m0, s43, 3072
s_mov_b32 s69, 172032
buffer_load_dwordx4 v254, s[56:59], s69 offen nt lds
s_mov_b32 s67, 8
ds_read_b128 v[204:207], v6
s_waitcnt lgkmcnt(0)
v_max3_u32 v248, v204, v205, v206
v_max_u32 v248, v248, v207
v_cmp_eq_u32 s[98:99], -1, v248
s_cmp_eq_u64 s[98:99], 0
s_cbranch_scc1 L_qk
s_cbranch_vccnz L_th55
s_waitcnt vmcnt(3)
L_th55:
s_waitcnt vmcnt(5)
s_add_u32 s69, s65, 35840
buffer_load_dwordx4 v[176:179], v2, s[48:51], s69 offen nt
s_mov_b32 s67, 9
ds_read_b128 v[204:207], v6
s_waitcnt lgkmcnt(0)
v_max3_u32 v248, v204, v205, v206
v_max_u32 v248, v248, v207
v_cmp_eq_u32 s[98:99], -1, v248
s_cmp_eq_u64 s[98:99], 0
s_cbranch_scc1 L_qk
s_cbranch_vccnz L_th56
s_waitcnt vmcnt(3)
L_th56:
s_waitcnt vmcnt(5)
s_add_u32 s69, s65, 43008
buffer_load_dwordx4 v[180:183], v2, s[48:51], s69 offen nt
s_mov_b32 s67, 10
ds_read_b128 v[204:207], v6
s_waitcnt lgkmcnt(0)
v_max3_u32 v248, v204, v205, v206
v_max_u32 v248, v248, v207
v_cmp_eq_u32 s[98:99], -1, v248
s_cmp_eq_u64 s[98:99], 0
s_cbranch_scc1 L_qk
s_cbranch_vccnz L_th57
s_waitcnt vmcnt(3)
L_th57:
s_waitcnt vmcnt(5)
s_add_u32 s69, s65, 50176
buffer_load_dwordx4 v[184:187], v2, s[48:51], s69 offen nt
s_mov_b32 s67, 11
ds_read_b128 v[204:207], v6
s_waitcnt lgkmcnt(0)
v_max3_u32 v248, v204, v205, v206
v_max_u32 v248, v248, v207
v_cmp_eq_u32 s[98:99], -1, v248
s_cmp_eq_u64 s[98:99], 0
s_cbranch_scc1 L_qk
s_cbranch_vccnz L_th58
s_waitcnt vmcnt(3)
L_th58:
s_waitcnt vmcnt(5)
s_add_u32 s69, s65, 57344
buffer_load_dwordx4 v[188:191], v2, s[48:51], s69 offen nt
s_mov_b32 s67, 12
ds_read_b128 v[204:207], v6
s_waitcnt lgkmcnt(0)
v_max3_u32 v248, v204, v205, v206
v_max_u32 v248, v248, v207
v_cmp_eq_u32 s[98:99], -1, v248
s_cmp_eq_u64 s[98:99], 0
s_cbranch_scc1 L_qk
s_cbranch_vccnz L_th59
s_waitcnt vmcnt(3)
L_th59:
s_waitcnt vmcnt(5)
s_add_u32 s69, s65, 64512
buffer_load_dwordx4 v[192:195], v2, s[48:51], s69 offen nt
s_mov_b32 s67, 13
ds_read_b128 v[204:207], v6
s_waitcnt lgkmcnt(0)
v_max3_u32 v248, v204, v205, v206
v_max_u32 v248, v248, v207
v_cmp_eq_u32 s[98:99], -1, v248
s_cmp_eq_u64 s[98:99], 0
s_cbranch_scc1 L_qk
s_cbranch_vccnz L_th60
s_waitcnt vmcnt(3)
L_th60:
s_waitcnt vmcnt(5)
s_add_u32 s69, s65, 71680
buffer_load_dwordx4 v[196:199], v2, s[48:51], s69 offen nt
s_mov_b32 s67, 14
ds_read_b128 v[204:207], v6
s_waitcnt lgkmcnt(0)
v_max3_u32 v248, v204, v205, v206
v_max_u32 v248, v248, v207
v_cmp_eq_u32 s[98:99], -1, v248
s_cmp_eq_u64 s[98:99], 0
s_cbranch_scc1 L_qk
s_cbranch_vccnz L_th61
s_waitcnt vmcnt(3)
L_th61:
s_waitcnt vmcnt(5)
s_add_u32 s69, s65, 78848
buffer_load_dwordx4 v[200:203], v2, s[48:51], s69 offen nt
s_mov_b32 s67, 15
L_qspin:
ds_read_b128 v[204:207], v6
s_waitcnt lgkmcnt(0)
v_max3_u32 v248, v204, v205, v206
v_max_u32 v248, v248, v207
v_cmp_eq_u32 s[98:99], -1, v248
s_cmp_eq_u64 s[98:99], 0
s_cbranch_scc1 L_qk
s_sub_u32 s66, s66, 1
s_cbranch_scc0 L_qspin
s_mov_b32 s66, 0
L_qk:
v_mov_b32 v7, 156176
ds_read_b32 v4, v7
s_waitcnt vmcnt(4)
v_mfma_f32_16x16x32_bf16 v[216:219], v[8:11], v[204:207], 0
v_mfma_f32_16x16x32_bf16 v[220:223], v[12:15], v[204:207], 0
v_mfma_f32_16x16x32_bf16 v[224:227], v[16:19], v[204:207], 0
v_mfma_f32_16x16x32_bf16 v[228:231], v[20:23], v[204:207], 0
v_mfma_f32_16x16x32_bf16 v[232:235], v[24:27], v[204:207], 0
v_mfma_f32_16x16x32_bf16 v[236:239], v[28:31], v[204:207], 0
v_mfma_f32_16x16x32_bf16 v[240:243], v[32:35], v[204:207], 0
v_mfma_f32_16x16x32_bf16 v[244:247], v[36:39], v[204:207], 0
s_nop 0
v_add_f32_dpp v248, v217, v216 quad_perm:[1,1,1,1] row_mask:0xf bank_mask:0xf
v_add_f32_dpp v249, v221, v220 quad_perm:[1,1,1,1] row_mask:0xf bank_mask:0xf
v_add_f32_dpp v250, v225, v224 quad_perm:[1,1,1,1] row_mask:0xf bank_mask:0xf
v_add_f32_dpp v251, v229, v228 quad_perm:[1,1,1,1] row_mask:0xf bank_mask:0xf
v_add_f32_dpp v248, v218, v248 quad_perm:[2,2,2,2] row_mask:0xf bank_mask:0xf
v_add_f32_dpp v249, v222, v249 quad_perm:[2,2,2,2] row_mask:0xf bank_mask:0xf
v_add_f32_dpp v250, v226, v250 quad_perm:[2,2,2,2] row_mask:0xf bank_mask:0xf
v_add_f32_dpp v251, v230, v251 quad_perm:[2,2,2,2] row_mask:0xf bank_mask:0xf
v_add_f32_dpp v248, v219, v248 quad_perm:[3,3,3,3] row_mask:0xf bank_mask:0xf
v_add_f32_dpp v249, v223, v249 quad_perm:[3,3,3,3] row_mask:0xf bank_mask:0xf
v_add_f32_dpp v250, v227, v250 quad_perm:[3,3,3,3] row_mask:0xf bank_mask:0xf
v_add_f32_dpp v251, v231, v251 quad_perm:[3,3,3,3] row_mask:0xf bank_mask:0xf
v_permlane16_swap_b32 v248, v249
s_nop 0
v_permlane16_swap_b32 v250, v251
s_mov_b64 exec, s[70:71]
v_add_f32_dpp v212, v249, v248 row_shl:4 row_mask:0xf bank_mask:0x5
s_nop 1
v_add_f32_dpp v212, v250, v251 row_shr:4 row_mask:0xf bank_mask:0xa
s_mov_b64 exec, -1
v_mfma_f32_16x16x32_bf16 v[216:219], v[40:43], v[204:207], 0
v_mfma_f32_16x16x32_bf16 v[220:223], v[44:47], v[204:207], 0
v_mfma_f32_16x16x32_bf16 v[224:227], v[48:51], v[204:207], 0
v_mfma_f32_16x16x32_bf16 v[228:231], v[52:55], v[204:207], 0
v_add_f32_dpp v248, v232, v233 quad_perm:[0,0,0,0] row_mask:0xf bank_mask:0xf
v_add_f32_dpp v249, v236, v237 quad_perm:[0,0,0,0] row_mask:0xf bank_mask:0xf
v_add_f32_dpp v250, v240, v241 quad_perm:[0,0,0,0] row_mask:0xf bank_mask:0xf
v_add_f32_dpp v251, v244, v245 quad_perm:[0,0,0,0] row_mask:0xf bank_mask:0xf
v_add_f32_dpp v248, v234, v248 quad_perm:[2,2,2,2] row_mask:0xf bank_mask:0xf
v_add_f32_dpp v249, v238, v249 quad_perm:[2,2,2,2] row_mask:0xf bank_mask:0xf
v_add_f32_dpp v250, v242, v250 quad_perm:[2,2,2,2] row_mask:0xf bank_mask:0xf
v_add_f32_dpp v251, v246, v251 quad_perm:[2,2,2,2] row_mask:0xf bank_mask:0xf
v_add_f32_dpp v248, v235, v248 quad_perm:[3,3,3,3] row_mask:0xf bank_mask:0xf
v_add_f32_dpp v249, v239, v249 quad_perm:[3,3,3,3] row_mask:0xf bank_mask:0xf
v_add_f32_dpp v250, v243, v250 quad_perm:[3,3,3,3] row_mask:0xf bank_mask:0xf
v_add_f32_dpp v251, v247, v251 quad_perm:[3,3,3,3] row_mask:0xf bank_mask:0xf
v_permlane16_swap_b32 v248, v249
s_nop 0
v_permlane16_swap_b32 v250, v251
s_mov_b64 exec, s[72:73]
v_add_f32_dpp v212, v249, v248 row_shl:4 row_mask:0xf bank_mask:0x5
s_nop 1
v_add_f32_dpp v212, v250, v251 row_shr:4 row_mask:0xf bank_mask:0xa
s_mov_b64 exec, -1
s_add_u32 s69, s65, 86016
buffer_load_dwordx4 v[8:11], v2, s[48:51], s69 offen nt
v_mfma_f32_16x16x32_bf16 v[232:235], v[56:59], v[204:207], 0
v_mfma_f32_16x16x32_bf16 v[236:239], v[60:63], v[204:207], 0
v_mfma_f32_16x16x32_bf16 v[240:243], v[64:67], v[204:207], 0
v_mfma_f32_16x16x32_bf16 v[244:247], v[68:71], v[204:207], 0
v_add_f32_dpp v248, v216, v218 quad_perm:[0,0,0,0] row_mask:0xf bank_mask:0xf
v_add_f32_dpp v249, v220, v222 quad_perm:[0,0,0,0] row_mask:0xf bank_mask:0xf
v_add_f32_dpp v250, v224, v226 quad_perm:[0,0,0,0] row_mask:0xf bank_mask:0xf
v_add_f32_dpp v251, v228, v230 quad_perm:[0,0,0,0] row_mask:0xf bank_mask:0xf
v_add_f32_dpp v248, v217, v248 quad_perm:[1,1,1,1] row_mask:0xf bank_mask:0xf
v_add_f32_dpp v249, v221, v249 quad_perm:[1,1,1,1] row_mask:0xf bank_mask:0xf
v_add_f32_dpp v250, v225, v250 quad_perm:[1,1,1,1] row_mask:0xf bank_mask:0xf
v_add_f32_dpp v251, v229, v251 quad_perm:[1,1,1,1] row_mask:0xf bank_mask:0xf
v_add_f32_dpp v248, v219, v248 quad_perm:[3,3,3,3] row_mask:0xf bank_mask:0xf
v_add_f32_dpp v249, v223, v249 quad_perm:[3,3,3,3] row_mask:0xf bank_mask:0xf
v_add_f32_dpp v250, v227, v250 quad_perm:[3,3,3,3] row_mask:0xf bank_mask:0xf
v_add_f32_dpp v251, v231, v251 quad_perm:[3,3,3,3] row_mask:0xf bank_mask:0xf
v_permlane16_swap_b32 v248, v249
s_nop 0
v_permlane16_swap_b32 v250, v251
s_mov_b64 exec, s[74:75]
v_add_f32_dpp v212, v249, v248 row_shl:4 row_mask:0xf bank_mask:0x5
s_nop 1
v_add_f32_dpp v212, v250, v251 row_shr:4 row_mask:0xf bank_mask:0xa
s_mov_b64 exec, -1
v_mfma_f32_16x16x32_bf16 v[216:219], v[72:75], v[204:207], 0
v_mfma_f32_16x16x32_bf16 v[220:223], v[76:79], v[204:207], 0
v_mfma_f32_16x16x32_bf16 v[224:227], v[80:83], v[204:207], 0
v_mfma_f32_16x16x32_bf16 v[228:231], v[84:87], v[204:207], 0
v_add_f32_dpp v248, v232, v235 quad_perm:[0,0,0,0] row_mask:0xf bank_mask:0xf
v_add_f32_dpp v249, v236, v239 quad_perm:[0,0,0,0] row_mask:0xf bank_mask:0xf
v_add_f32_dpp v250, v240, v243 quad_perm:[0,0,0,0] row_mask:0xf bank_mask:0xf
v_add_f32_dpp v251, v244, v247 quad_perm:[0,0,0,0] row_mask:0xf bank_mask:0xf
v_add_f32_dpp v248, v233, v248 quad_perm:[1,1,1,1] row_mask:0xf bank_mask:0xf
v_add_f32_dpp v249, v237, v249 quad_perm:[1,1,1,1] row_mask:0xf bank_mask:0xf
v_add_f32_dpp v250, v241, v250 quad_perm:[1,1,1,1] row_mask:0xf bank_mask:0xf
v_add_f32_dpp v251, v245, v251 quad_perm:[1,1,1,1] row_mask:0xf bank_mask:0xf
v_add_f32_dpp v248, v234, v248 quad_perm:[2,2,2,2] row_mask:0xf bank_mask:0xf
v_add_f32_dpp v249, v238, v249 quad_perm:[2,2,2,2] row_mask:0xf bank_mask:0xf
v_add_f32_dpp v250, v242, v250 quad_perm:[2,2,2,2] row_mask:0xf bank_mask:0xf
v_add_f32_dpp v251, v246, v251 quad_perm:[2,2,2,2] row_mask:0xf bank_mask:0xf
v_permlane16_swap_b32 v248, v249
s_nop 0
v_permlane16_swap_b32 v250, v251
s_mov_b64 exec, s[76:77]
v_add_f32_dpp v212, v249, v248 row_shl:4 row_mask:0xf bank_mask:0x5
s_nop 1
v_add_f32_dpp v212, v250, v251 row_shr:4 row_mask:0xf bank_mask:0xa
s_mov_b64 exec, -1
s_add_u32 s69, s65, 93184
buffer_load_dwordx4 v[12:15], v2, s[48:51], s69 offen nt
v_mfma_f32_16x16x32_bf16 v[232:235], v[88:91], v[204:207], 0
v_mfma_f32_16x16x32_bf16 v[236:239], v[92:95], v[204:207], 0
v_mfma_f32_16x16x32_bf16 v[240:243], v[96:99], v[204:207], 0
v_mfma_f32_16x16x32_bf16 v[244:247], v[100:103], v[204:207], 0
v_add_f32_dpp v248, v217, v216 quad_perm:[1,1,1,1] row_mask:0xf bank_mask:0xf
v_add_f32_dpp v249, v221, v220 quad_perm:[1,1,1,1] row_mask:0xf bank_mask:0xf
v_add_f32_dpp v250, v225, v224 quad_perm:[1,1,1,1] row_mask:0xf bank_mask:0xf
v_add_f32_dpp v251, v229, v228 quad_perm:[1,1,1,1] row_mask:0xf bank_mask:0xf
v_add_f32_dpp v248, v218, v248 quad_perm:[2,2,2,2] row_mask:0xf bank_mask:0xf
v_add_f32_dpp v249, v222, v249 quad_perm:[2,2,2,2] row_mask:0xf bank_mask:0xf
v_add_f32_dpp v250, v226, v250 quad_perm:[2,2,2,2] row_mask:0xf bank_mask:0xf
v_add_f32_dpp v251, v230, v251 quad_perm:[2,2,2,2] row_mask:0xf bank_mask:0xf
v_add_f32_dpp v248, v219, v248 quad_perm:[3,3,3,3] row_mask:0xf bank_mask:0xf
v_add_f32_dpp v249, v223, v249 quad_perm:[3,3,3,3] row_mask:0xf bank_mask:0xf
v_add_f32_dpp v250, v227, v250 quad_perm:[3,3,3,3] row_mask:0xf bank_mask:0xf
v_add_f32_dpp v251, v231, v251 quad_perm:[3,3,3,3] row_mask:0xf bank_mask:0xf
v_permlane16_swap_b32 v248, v249
s_nop 0
v_permlane16_swap_b32 v250, v251
s_mov_b64 exec, s[70:71]
v_add_f32_dpp v213, v249, v248 row_shl:4 row_mask:0xf bank_mask:0x5
s_nop 1
v_add_f32_dpp v213, v250, v251 row_shr:4 row_mask:0xf bank_mask:0xa
s_mov_b64 exec, -1
v_mfma_f32_16x16x32_bf16 v[216:219], v[104:107], v[204:207], 0
v_mfma_f32_16x16x32_bf16 v[220:223], v[108:111], v[204:207], 0
v_mfma_f32_16x16x32_bf16 v[224:227], v[112:115], v[204:207], 0
v_mfma_f32_16x16x32_bf16 v[228:231], v[116:119], v[204:207], 0
v_add_f32_dpp v248, v232, v233 quad_perm:[0,0,0,0] row_mask:0xf bank_mask:0xf
v_add_f32_dpp v249, v236, v237 quad_perm:[0,0,0,0] row_mask:0xf bank_mask:0xf
v_add_f32_dpp v250, v240, v241 quad_perm:[0,0,0,0] row_mask:0xf bank_mask:0xf
v_add_f32_dpp v251, v244, v245 quad_perm:[0,0,0,0] row_mask:0xf bank_mask:0xf
v_add_f32_dpp v248, v234, v248 quad_perm:[2,2,2,2] row_mask:0xf bank_mask:0xf
v_add_f32_dpp v249, v238, v249 quad_perm:[2,2,2,2] row_mask:0xf bank_mask:0xf
v_add_f32_dpp v250, v242, v250 quad_perm:[2,2,2,2] row_mask:0xf bank_mask:0xf
v_add_f32_dpp v251, v246, v251 quad_perm:[2,2,2,2] row_mask:0xf bank_mask:0xf
v_add_f32_dpp v248, v235, v248 quad_perm:[3,3,3,3] row_mask:0xf bank_mask:0xf
v_add_f32_dpp v249, v239, v249 quad_perm:[3,3,3,3] row_mask:0xf bank_mask:0xf
v_add_f32_dpp v250, v243, v250 quad_perm:[3,3,3,3] row_mask:0xf bank_mask:0xf
v_add_f32_dpp v251, v247, v251 quad_perm:[3,3,3,3] row_mask:0xf bank_mask:0xf
v_permlane16_swap_b32 v248, v249
s_nop 0
v_permlane16_swap_b32 v250, v251
s_mov_b64 exec, s[72:73]
v_add_f32_dpp v213, v249, v248 row_shl:4 row_mask:0xf bank_mask:0x5
s_nop 1
v_add_f32_dpp v213, v250, v251 row_shr:4 row_mask:0xf bank_mask:0xa
s_mov_b64 exec, -1
s_add_u32 s69, s65, 100352
buffer_load_dwordx4 v[16:19], v2, s[48:51], s69 offen nt
v_mfma_f32_16x16x32_bf16 v[232:235], v[120:123], v[204:207], 0
v_mfma_f32_16x16x32_bf16 v[236:239], v[124:127], v[204:207], 0
v_mfma_f32_16x16x32_bf16 v[240:243], v[128:131], v[204:207], 0
v_mfma_f32_16x16x32_bf16 v[244:247], v[132:135], v[204:207], 0
v_add_f32_dpp v248, v216, v218 quad_perm:[0,0,0,0] row_mask:0xf bank_mask:0xf
v_add_f32_dpp v249, v220, v222 quad_perm:[0,0,0,0] row_mask:0xf bank_mask:0xf
v_add_f32_dpp v250, v224, v226 quad_perm:[0,0,0,0] row_mask:0xf bank_mask:0xf
v_add_f32_dpp v251, v228, v230 quad_perm:[0,0,0,0] row_mask:0xf bank_mask:0xf
v_add_f32_dpp v248, v217, v248 quad_perm:[1,1,1,1] row_mask:0xf bank_mask:0xf
v_add_f32_dpp v249, v221, v249 quad_perm:[1,1,1,1] row_mask:0xf bank_mask:0xf
v_add_f32_dpp v250, v225, v250 quad_perm:[1,1,1,1] row_mask:0xf bank_mask:0xf
v_add_f32_dpp v251, v229, v251 quad_perm:[1,1,1,1] row_mask:0xf bank_mask:0xf
v_add_f32_dpp v248, v219, v248 quad_perm:[3,3,3,3] row_mask:0xf bank_mask:0xf
v_add_f32_dpp v249, v223, v249 quad_perm:[3,3,3,3] row_mask:0xf bank_mask:0xf
v_add_f32_dpp v250, v227, v250 quad_perm:[3,3,3,3] row_mask:0xf bank_mask:0xf
v_add_f32_dpp v251, v231, v251 quad_perm:[3,3,3,3] row_mask:0xf bank_mask:0xf
v_permlane16_swap_b32 v248, v249
s_nop 0
v_permlane16_swap_b32 v250, v251
s_mov_b64 exec, s[74:75]
v_add_f32_dpp v213, v249, v248 row_shl:4 row_mask:0xf bank_mask:0x5
s_nop 1
v_add_f32_dpp v213, v250, v251 row_shr:4 row_mask:0xf bank_mask:0xa
s_mov_b64 exec, -1
v_mfma_f32_16x16x32_bf16 v[216:219], v[136:139], v[204:207], 0
v_mfma_f32_16x16x32_bf16 v[220:223], v[140:143], v[204:207], 0
v_mfma_f32_16x16x32_bf16 v[224:227], v[144:147], v[204:207], 0
v_mfma_f32_16x16x32_bf16 v[228:231], v[148:151], v[204:207], 0
v_add_f32_dpp v248, v232, v235 quad_perm:[0,0,0,0] row_mask:0xf bank_mask:0xf
v_add_f32_dpp v249, v236, v239 quad_perm:[0,0,0,0] row_mask:0xf bank_mask:0xf
v_add_f32_dpp v250, v240, v243 quad_perm:[0,0,0,0] row_mask:0xf bank_mask:0xf
v_add_f32_dpp v251, v244, v247 quad_perm:[0,0,0,0] row_mask:0xf bank_mask:0xf
v_add_f32_dpp v248, v233, v248 quad_perm:[1,1,1,1] row_mask:0xf bank_mask:0xf
v_add_f32_dpp v249, v237, v249 quad_perm:[1,1,1,1] row_mask:0xf bank_mask:0xf
v_add_f32_dpp v250, v241, v250 quad_perm:[1,1,1,1] row_mask:0xf bank_mask:0xf
v_add_f32_dpp v251, v245, v251 quad_perm:[1,1,1,1] row_mask:0xf bank_mask:0xf
v_add_f32_dpp v248, v234, v248 quad_perm:[2,2,2,2] row_mask:0xf bank_mask:0xf
v_add_f32_dpp v249, v238, v249 quad_perm:[2,2,2,2] row_mask:0xf bank_mask:0xf
v_add_f32_dpp v250, v242, v250 quad_perm:[2,2,2,2] row_mask:0xf bank_mask:0xf
v_add_f32_dpp v251, v246, v251 quad_perm:[2,2,2,2] row_mask:0xf bank_mask:0xf
v_permlane16_swap_b32 v248, v249
s_nop 0
v_permlane16_swap_b32 v250, v251
s_mov_b64 exec, s[76:77]
v_add_f32_dpp v213, v249, v248 row_shl:4 row_mask:0xf bank_mask:0x5
s_nop 1
v_add_f32_dpp v213, v250, v251 row_shr:4 row_mask:0xf bank_mask:0xa
s_mov_b64 exec, -1
s_add_u32 s69, s65, 107520
buffer_load_dwordx4 v[20:23], v2, s[48:51], s69 offen nt
v_mfma_f32_16x16x32_bf16 v[232:235], v[152:155], v[204:207], 0
v_add_f32_dpp v248, v217, v216 quad_perm:[1,1,1,1] row_mask:0xf bank_mask:0xf
v_add_f32_dpp v249, v221, v220 quad_perm:[1,1,1,1] row_mask:0xf bank_mask:0xf
v_add_f32_dpp v250, v225, v224 quad_perm:[1,1,1,1] row_mask:0xf bank_mask:0xf
v_add_f32_dpp v251, v229, v228 quad_perm:[1,1,1,1] row_mask:0xf bank_mask:0xf
v_add_f32_dpp v248, v218, v248 quad_perm:[2,2,2,2] row_mask:0xf bank_mask:0xf
v_add_f32_dpp v249, v222, v249 quad_perm:[2,2,2,2] row_mask:0xf bank_mask:0xf
v_add_f32_dpp v250, v226, v250 quad_perm:[2,2,2,2] row_mask:0xf bank_mask:0xf
v_add_f32_dpp v251, v230, v251 quad_perm:[2,2,2,2] row_mask:0xf bank_mask:0xf
v_add_f32_dpp v248, v219, v248 quad_perm:[3,3,3,3] row_mask:0xf bank_mask:0xf
v_add_f32_dpp v249, v223, v249 quad_perm:[3,3,3,3] row_mask:0xf bank_mask:0xf
v_add_f32_dpp v250, v227, v250 quad_perm:[3,3,3,3] row_mask:0xf bank_mask:0xf
v_add_f32_dpp v251, v231, v251 quad_perm:[3,3,3,3] row_mask:0xf bank_mask:0xf
v_permlane16_swap_b32 v248, v249
s_nop 0
v_permlane16_swap_b32 v250, v251
s_mov_b64 exec, s[70:71]
v_add_f32_dpp v214, v249, v248 row_shl:4 row_mask:0xf bank_mask:0x5
s_nop 1
v_add_f32_dpp v214, v250, v251 row_shr:4 row_mask:0xf bank_mask:0xa
s_mov_b64 exec, -1
v_add_f32_dpp v248, v232, v233 quad_perm:[0,0,0,0] row_mask:0xf bank_mask:0xf
s_nop 1
v_add_f32_dpp v248, v234, v248 quad_perm:[2,2,2,2] row_mask:0xf bank_mask:0xf
s_nop 1
v_add_f32_dpp v248, v235, v248 quad_perm:[3,3,3,3] row_mask:0xf bank_mask:0xf
s_nop 1
v_permlane16_swap_b32 v248, v249
s_mov_b64 exec, s[72:73]
s_nop 0
v_add_f32_dpp v214, v249, v248 row_shl:4 row_mask:0x5 bank_mask:0x5
s_mov_b64 exec, -1
ds_bpermute_b32 v212, v215, v212
ds_bpermute_b32 v213, v215, v213
ds_bpermute_b32 v214, v215, v214
s_mov_b32 s12, 0x3db8aa3b
s_waitcnt lgkmcnt(0)
s_mov_b64 exec, s[78:79]
v_mov_b32 v214, 0xff800000
s_mov_b64 exec, -1
v_cvt_pk_bf16_f32 v212, 0, v212
v_cvt_pk_bf16_f32 v213, 0, v213
v_cvt_pk_bf16_f32 v214, 0, v214
v_max3_f32 v248, v212, v213, v214
s_nop 1
v_max_f32_dpp v248, v248, v248 row_ror:8 row_mask:0xf bank_mask:0xf
s_nop 1
v_max_f32_dpp v248, v248, v248 row_ror:4 row_mask:0xf bank_mask:0xf
s_nop 1
v_max_f32_dpp v248, v248, v248 row_ror:2 row_mask:0xf bank_mask:0xf
s_nop 1
v_max_f32_dpp v248, v248, v248 row_ror:1 row_mask:0xf bank_mask:0xf
v_mov_b32 v250, v248
s_nop 1
v_permlane32_swap_b32 v248, v250
v_max_f32 v248, v248, v250
v_sub_f32 v216, v212, v248
v_sub_f32 v217, v213, v248
v_sub_f32 v218, v214, v248
v_mul_f32 v216, s12, v216
v_mul_f32 v217, s12, v217
v_mul_f32 v218, s12, v218
v_exp_f32 v216, v216
v_exp_f32 v217, v217
v_exp_f32 v218, v218
v_add_f32 v249, v216, v217
v_add_f32 v249, v249, v218
s_nop 1
v_add_f32_dpp v249, v249, v249 row_ror:8 row_mask:0xf bank_mask:0xf
s_nop 1
v_add_f32_dpp v249, v249, v249 row_ror:4 row_mask:0xf bank_mask:0xf
s_nop 1
v_add_f32_dpp v249, v249, v249 row_ror:2 row_mask:0xf bank_mask:0xf
s_nop 1
v_add_f32_dpp v249, v249, v249 row_ror:1 row_mask:0xf bank_mask:0xf
v_mov_b32 v250, v249
s_nop 1
v_permlane32_swap_b32 v249, v250
v_add_f32 v249, v249, v250
v_readfirstlane_b32 s68, v4
s_mov_b32 exec_lo, 0x00010001
s_mov_b32 exec_hi, 0
s_cmp_eq_u32 s68, 1
s_cbranch_scc1 L_st_near
global_store_dwordx2 v3, v[248:249], s[40:41] sc1
s_branch L_st_done
L_st_near:
global_store_dwordx2 v3, v[248:249], s[40:41]
L_st_done:
s_mov_b64 exec, -1
s_lshl_b32 s11, s3, 13
v_lshrrev_b32 v153, 4, v0
v_bfe_u32 v154, v0, 2, 2
v_and_b32 v155, 3, v0
v_lshrrev_b32 v129, 1, v154
v_and_b32 v128, 1, v153
v_lshl_or_b32 v129, v128, 1, v129
v_lshl_add_u32 v127, v153, 3, v154
v_lshlrev_b32 v126, 7, v127
v_lshl_add_u32 v126, v155, 3, v126
v_add_u32 v149, s11, v126
v_lshl_add_u32 v149, v153, 10, v149
v_and_b32 v129, 1, v129
v_xor_b32 v150, 0, v129
v_lshl_add_u32 v124, v150, 5, v149
v_xor_b32 v150, 1, v129
v_lshl_add_u32 v125, v150, 5, v149
v_xor_b32 v150, 2, v129
v_lshl_add_u32 v126, v150, 5, v149
v_xor_b32 v150, 3, v129
v_lshl_add_u32 v151, v150, 5, v149
s_lshl_b32 s11, s3, 12
s_add_u32 s12, s11, 65536
v_lshrrev_b32 v150, 1, v153
v_lshlrev_b32 v150, 4, v150
v_add_u32 v150, v128, v150
v_lshl_add_u32 v150, v154, 1, v150
v_lshlrev_b32 v150, 7, v150
v_lshrrev_b32 v128, 1, v154
v_lshl_add_u32 v150, v155, 3, v150
v_add_u32 v150, s12, v150
v_mov_b32 v127, v151
v_xor_b32 v129, 1, v128
v_lshl_add_u32 v129, v129, 5, v150
v_lshl_add_u32 v128, v128, 5, v150
s_mul_i32 s12, s3, 2112
s_add_u32 s12, s12, 122880
v_and_b32 v150, 31, v0
v_lshlrev_b32 v150, 5, v150
v_lshrrev_b32 v151, 5, v0
v_lshl_add_u32 v150, v151, 4, v150
v_add_u32 v133, s12, v150
s_lshl_b32 s12, s3, 8
v_mul_u32_u24 v134, 2112, v153
v_and_b32 v150, 15, v0
v_lshl_add_u32 v134, v150, 2, v134
s_add_u32 s13, s12, 122880
v_add_u32 v134, s13, v134
v_add_u32 v130, 8448, v134
v_lshl_add_u32 v150, v0, 2, s12
s_lshl_b32 s13, s9, 14
s_add_u32 s13, s13, 188416
s_lshl_b32 s14, s7, 11
s_add_u32 s14, s14, s13
v_add_u32 v135, s14, v150
s_add_u32 s13, s13, s12
v_and_b32 v150, 7, v0
v_lshrrev_b32 v151, 3, v0
v_lshlrev_b32 v152, 11, v154
v_lshl_add_u32 v152, v153, 6, v152
v_lshl_add_u32 v152, v155, 4, v152
v_add_u32 v136, s13, v152
v_add_u32 v131, 8192, v136
s_add_u32 s13, s12, 157184
v_lshlrev_b32 v152, 4, v153
v_add_u32 v137, s13, v152
v_and_b32 v138, 15, v0
v_lshlrev_b32 v138, 4, v138
s_lshl_b32 s13, s6, 3
s_add_u32 s14, s13, s4
s_mul_i32 s14, s14, 1792
s_lshl_b32 s15, s7, 8
s_add_u32 s14, s14, s15
s_add_u32 s14, s14, 131072
v_add_u32 v139, s14, v138
v_add_u32 v138, 157184, v138
s_mul_i32 s13, s13, 1792
s_add_u32 s13, s13, s12
s_add_u32 s13, s13, 131072
v_mul_u32_u24 v140, 1792, v151
v_lshl_add_u32 v140, v150, 4, v140
v_add_u32 v140, s13, v140
v_lshrrev_b32 v152, 5, v0
v_lshlrev_b32 v152, 5, v152
v_lshl_add_u32 v152, v150, 2, v152
v_bfe_u32 v151, v0, 4, 1
v_lshl_add_u32 v152, v151, 1, v152
v_bfe_u32 v151, v0, 3, 1
v_add_u32 v152, v151, v152
v_lshlrev_b32 v141, 2, v152
v_add_u32 v141, s12, v141
v_add_u32 v141, 0x20000, v141
s_lshl_b32 s13, s3, 7
s_add_u32 s13, s13, 156288
v_lshlrev_b32 v142, 1, v152
v_add_u32 v142, s13, v142
v_lshlrev_b32 v152, 4, v153
v_add_u32 v143, s13, v152
s_mul_i32 s13, s3, 144
s_add_u32 s13, s13, 159232
v_add_u32 v144, s13, v152
v_bfe_u32 v145, v0, 1, 3
v_mul_u32_u24 v145, 144, v145
v_and_b32 v146, 1, v0
v_lshl_add_u32 v145, v146, 4, v145
v_lshl_add_u32 v145, v153, 5, v145
v_add_u32 v145, 159232, v145
s_mul_i32 s13, s6, 14
s_lshl_b32 s14, s3, 1
s_add_u32 s14, s14, s13
s_mul_i32 s14, s14, 56
s_add_u32 s14, s14, s10
s_lshl_b32 s14, s14, 7
s_add_u32 s14, s14, 712704
v_lshrrev_b32 v146, 5, v0
v_mul_u32_u24 v146, 7168, v146
v_lshl_add_u32 v146, v155, 4, v146
v_and_b32 v149, 1, v153
v_lshl_add_u32 v146, v149, 6, v146
v_add_u32 v146, s14, v146
s_lshr_b32 s14, s10, 1
s_add_u32 s13, s13, s14
s_mul_i32 s13, s13, 7168
s_and_b32 s14, s10, 1
s_lshl_b32 s14, s14, 6
s_add_u32 s13, s13, s14
s_add_u32 s13, s13, 716800
v_lshrrev_b32 v147, 2, v0
v_lshlrev_b32 v147, 7, v147
v_lshl_add_u32 v147, v155, 4, v147
v_add_u32 v147, s13, v147
v_lshlrev_b32 v148, 2, v155
v_lshrrev_b32 v152, 5, v0
v_lshl_add_u32 v148, v152, 1, v148
v_bfe_u32 v152, v0, 4, 1
v_add_u32 v148, v152, v148
s_lshl_b32 s13, s10, 4
v_add_u32 v148, s13, v148
s_lshl_b32 s13, s3, 4
s_add_u32 s13, s13, 160384
v_lshrrev_b32 v132, 5, v0
v_and_b32 v149, 1, v0
v_lshl_add_u32 v132, v132, 1, v149
v_lshl_add_u32 v132, v132, 2, s13
v_add_u32 v149, 1, v0
v_and_b32 v149, 7, v149
v_lshlrev_b32 v150, 4, v149
v_add_u32 v150, 160368, v150
v_min_u32 v151, 1, v149
v_cvt_f32_u32 v151, v151
v_mul_f32 v151, 0x42800000, v151
s_sub_u32 s13, 94208, s11
v_lshrrev_b32 v152, 1, v154
v_and_b32 v149, 1, v153
v_lshl_or_b32 v152, v149, 1, v152
v_xor_b32 v152, v155, v152
v_lshlrev_b32 v152, 5, v152
v_lshl_add_u32 v149, v153, 3, v154
v_lshl_add_u32 v152, v149, 7, v152
s_add_u32 s13, s11, 94208
v_add_u32 v152, s13, v152
s_cmp_gt_u32 s67, 3
s_cbranch_scc1 L_esk3
s_cbranch_vccnz L_th62
s_waitcnt vmcnt(3)
L_th62:
s_waitcnt vmcnt(5)
s_add_u32 m0, s43, 1024
s_mov_b32 s69, 57344
buffer_load_dwordx4 v254, s[56:59], s69 offen nt lds
L_esk3:
s_cmp_gt_u32 s67, 4
s_cbranch_scc1 L_esk4
s_cbranch_vccnz L_th63
s_waitcnt vmcnt(3)
L_th63:
s_waitcnt vmcnt(5)
s_add_u32 s69, s65, 21504
buffer_load_dwordx4 v[168:171], v2, s[48:51], s69 offen nt
L_esk4:
s_cmp_gt_u32 s67, 5
s_cbranch_scc1 L_esk5
s_cbranch_vccnz L_th64
s_waitcnt vmcnt(3)
L_th64:
s_waitcnt vmcnt(5)
s_add_u32 m0, s43, 2048
s_mov_b32 s69, 114688
buffer_load_dwordx4 v254, s[56:59], s69 offen nt lds
L_esk5:
s_cmp_gt_u32 s67, 6
s_cbranch_scc1 L_esk6
s_cbranch_vccnz L_th65
s_waitcnt vmcnt(3)
L_th65:
s_waitcnt vmcnt(5)
s_add_u32 s69, s65, 28672
buffer_load_dwordx4 v[172:175], v2, s[48:51], s69 offen nt
L_esk6:
s_cmp_gt_u32 s67, 7
s_cbranch_scc1 L_esk7
s_cbranch_vccnz L_th66
s_waitcnt vmcnt(3)
L_th66:
s_waitcnt vmcnt(5)
s_add_u32 m0, s43, 3072
s_mov_b32 s69, 172032
buffer_load_dwordx4 v254, s[56:59], s69 offen nt lds
L_esk7:
s_cmp_gt_u32 s67, 8
s_cbranch_scc1 L_esk8
s_cbranch_vccnz L_th67
s_waitcnt vmcnt(3)
L_th67:
s_waitcnt vmcnt(5)
s_add_u32 s69, s65, 35840
buffer_load_dwordx4 v[176:179], v2, s[48:51], s69 offen nt
L_esk8:
s_cmp_gt_u32 s67, 9
s_cbranch_scc1 L_esk9
s_cbranch_vccnz L_th68
s_waitcnt vmcnt(3)
L_th68:
s_waitcnt vmcnt(5)
s_add_u32 s69, s65, 43008
buffer_load_dwordx4 v[180:183], v2, s[48:51], s69 offen nt
L_esk9:
s_cmp_gt_u32 s67, 10
s_cbranch_scc1 L_esk10
s_cbranch_vccnz L_th69
s_waitcnt vmcnt(3)
L_th69:
s_waitcnt vmcnt(5)
s_add_u32 s69, s65, 50176
buffer_load_dwordx4 v[184:187], v2, s[48:51], s69 offen nt
L_esk10:
s_cmp_gt_u32 s67, 11
s_cbranch_scc1 L_esk11
s_cbranch_vccnz L_th70
s_waitcnt vmcnt(3)
L_th70:
s_waitcnt vmcnt(5)
s_add_u32 s69, s65, 57344
buffer_load_dwordx4 v[188:191], v2, s[48:51], s69 offen nt
L_esk11:
s_cmp_gt_u32 s67, 12
s_cbranch_scc1 L_esk12
s_cbranch_vccnz L_th71
s_waitcnt vmcnt(3)
L_th71:
s_waitcnt vmcnt(5)
s_add_u32 s69, s65, 64512
buffer_load_dwordx4 v[192:195], v2, s[48:51], s69 offen nt
L_esk12:
s_cmp_gt_u32 s67, 13
s_cbranch_scc1 L_esk13
s_cbranch_vccnz L_th72
s_waitcnt vmcnt(3)
L_th72:
s_waitcnt vmcnt(5)
s_add_u32 s69, s65, 71680
buffer_load_dwordx4 v[196:199], v2, s[48:51], s69 offen nt
L_esk13:
s_cmp_gt_u32 s67, 14
s_cbranch_scc1 L_esk14
s_cbranch_vccnz L_th73
s_waitcnt vmcnt(3)
L_th73:
s_waitcnt vmcnt(5)
s_add_u32 s69, s65, 78848
buffer_load_dwordx4 v[200:203], v2, s[48:51], s69 offen nt
L_esk14:
s_cbranch_vccnz L_th74
s_waitcnt vmcnt(3)
L_th74:
s_waitcnt vmcnt(5)
s_add_u32 s69, s65, 114688
buffer_load_dwordx4 v[24:27], v2, s[48:51], s69 offen nt
s_cbranch_vccnz L_th75
s_waitcnt vmcnt(3)
L_th75:
s_waitcnt vmcnt(5)
s_add_u32 s69, s65, 121856
buffer_load_dwordx4 v[28:31], v2, s[48:51], s69 offen nt
s_cbranch_vccnz L_th76
s_waitcnt vmcnt(3)
L_th76:
s_waitcnt vmcnt(5)
s_add_u32 m0, s64, 0
s_mov_b32 s69, 0
buffer_load_dwordx4 v253, s[60:63], s69 offen nt lds
s_cmp_ge_u32 s2, 224
s_cselect_b64 s[98:99], 0, -1
s_cmp_lg_u32 s6, 1
s_cselect_b64 s[98:99], s[98:99], -1
s_and_b64 s[96:97], s[96:97], s[98:99]
s_and_b64 vcc, vcc, s[98:99]
s_cbranch_vccnz L_th77
s_waitcnt vmcnt(3)
L_th77:
s_waitcnt vmcnt(5)
s_add_u32 s69, s65, 129024
buffer_load_dwordx4 v[32:35], v2, s[48:51], s69 offen nt
s_cbranch_vccnz L_th78
s_waitcnt vmcnt(3)
L_th78:
s_waitcnt vmcnt(5)
s_add_u32 s69, s65, 136192
buffer_load_dwordx4 v[36:39], v2, s[48:51], s69 offen nt
s_cbranch_vccnz L_th79
s_waitcnt vmcnt(3)
L_th79:
s_waitcnt vmcnt(5)
s_add_u32 s69, s65, 143360
buffer_load_dwordx4 v[40:43], v2, s[48:51], s69 offen nt
s_cbranch_vccnz L_th80
s_waitcnt vmcnt(3)
L_th80:
s_waitcnt vmcnt(5)
s_add_u32 m0, s64, 1024
s_mov_b32 s69, 7168
buffer_load_dwordx4 v252, s[60:63], s69 offen nt lds
s_cbranch_vccnz L_th81
s_waitcnt vmcnt(3)
L_th81:
s_waitcnt vmcnt(5)
s_add_u32 s69, s65, 150528
buffer_load_dwordx4 v[44:47], v2, s[48:51], s69 offen nt
s_cbranch_vccnz L_th82
s_waitcnt vmcnt(3)
L_th82:
s_add_u32 s69, s65, 157696
buffer_load_dwordx4 v[48:51], v2, s[48:51], s69 offen nt
s_cbranch_vccnz L_th83
s_waitcnt vmcnt(3)
L_th83:
s_add_u32 s69, s65, 164864
buffer_load_dwordx4 v[52:55], v2, s[48:51], s69 offen nt
s_mov_b32 s67, 10
ds_read_b64 v[248:249], v5
s_waitcnt lgkmcnt(0)
v_max_u32 v250, v248, v249
v_cmp_eq_u32 s[98:99], -1, v250
s_cmp_eq_u64 s[98:99], 0
s_cbranch_scc1 L_pv
s_cbranch_vccnz L_th84
s_waitcnt vmcnt(3)
L_th84:
s_add_u32 s69, s65, 172032
buffer_load_dwordx4 v[56:59], v2, s[48:51], s69 offen nt
s_mov_b32 s67, 11
ds_read_b64 v[248:249], v5
s_waitcnt lgkmcnt(0)
v_max_u32 v250, v248, v249
v_cmp_eq_u32 s[98:99], -1, v250
s_cmp_eq_u64 s[98:99], 0
s_cbranch_scc1 L_pv
s_cbranch_vccnz L_th85
s_waitcnt vmcnt(3)
L_th85:
s_add_u32 m0, s64, 2048
s_mov_b32 s69, 14336
buffer_load_dwordx4 v253, s[60:63], s69 offen nt lds
s_mov_b32 s67, 12
ds_read_b64 v[248:249], v5
s_waitcnt lgkmcnt(0)
v_max_u32 v250, v248, v249
v_cmp_eq_u32 s[98:99], -1, v250
s_cmp_eq_u64 s[98:99], 0
s_cbranch_scc1 L_pv
s_cbranch_vccnz L_th86
s_waitcnt vmcnt(3)
L_th86:
s_add_u32 s69, s65, 179200
buffer_load_dwordx4 v[60:63], v2, s[48:51], s69 offen nt
s_mov_b32 s67, 13
ds_read_b64 v[248:249], v5
s_waitcnt lgkmcnt(0)
v_max_u32 v250, v248, v249
v_cmp_eq_u32 s[98:99], -1, v250
s_cmp_eq_u64 s[98:99], 0
s_cbranch_scc1 L_pv
s_cbranch_vccnz L_th87
s_waitcnt vmcnt(3)
L_th87:
s_add_u32 s69, s65, 186368
buffer_load_dwordx4 v[64:67], v2, s[48:51], s69 offen nt
s_mov_b32 s67, 14
ds_read_b64 v[248:249], v5
s_waitcnt lgkmcnt(0)
v_max_u32 v250, v248, v249
v_cmp_eq_u32 s[98:99], -1, v250
s_cmp_eq_u64 s[98:99], 0
s_cbranch_scc1 L_pv
s_cbranch_vccnz L_th88
s_waitcnt vmcnt(3)
L_th88:
s_waitcnt vmcnt(11)
s_add_u32 s69, s65, 193536
buffer_load_dwordx4 v[68:71], v2, s[48:51], s69 offen nt
s_mov_b32 s67, 15
ds_read_b64 v[248:249], v5
s_waitcnt lgkmcnt(0)
v_max_u32 v250, v248, v249
v_cmp_eq_u32 s[98:99], -1, v250
s_cmp_eq_u64 s[98:99], 0
s_cbranch_scc1 L_pv
s_cbranch_vccnz L_th89
s_waitcnt vmcnt(3)
L_th89:
s_waitcnt vmcnt(11)
s_add_u32 m0, s64, 3072
s_mov_b32 s69, 21504
buffer_load_dwordx4 v252, s[60:63], s69 offen nt lds
s_mov_b32 s67, 16
ds_read_b64 v[248:249], v5
s_waitcnt lgkmcnt(0)
v_max_u32 v250, v248, v249
v_cmp_eq_u32 s[98:99], -1, v250
s_cmp_eq_u64 s[98:99], 0
s_cbranch_scc1 L_pv
s_waitcnt vmcnt(11)
s_add_u32 s69, s65, 200704
buffer_load_dwordx4 v[72:75], v2, s[48:51], s69 offen nt
s_mov_b32 s67, 17
ds_read_b64 v[248:249], v5
s_waitcnt lgkmcnt(0)
v_max_u32 v250, v248, v249
v_cmp_eq_u32 s[98:99], -1, v250
s_cmp_eq_u64 s[98:99], 0
s_cbranch_scc1 L_pv
s_waitcnt vmcnt(11)
s_add_u32 s69, s65, 207872
buffer_load_dwordx4 v[76:79], v2, s[48:51], s69 offen nt
s_mov_b32 s67, 18
ds_read_b64 v[248:249], v5
s_waitcnt lgkmcnt(0)
v_max_u32 v250, v248, v249
v_cmp_eq_u32 s[98:99], -1, v250
s_cmp_eq_u64 s[98:99], 0
s_cbranch_scc1 L_pv
s_waitcnt vmcnt(11)
s_add_u32 s69, s65, 215040
buffer_load_dwordx4 v[80:83], v2, s[48:51], s69 offen nt
s_mov_b32 s67, 19
ds_read_b64 v[248:249], v5
s_waitcnt lgkmcnt(0)
v_max_u32 v250, v248, v249
v_cmp_eq_u32 s[98:99], -1, v250
s_cmp_eq_u64 s[98:99], 0
s_cbranch_scc1 L_pv
s_waitcnt vmcnt(11)
s_add_u32 s69, s65, 222208
buffer_load_dwordx4 v[84:87], v2, s[48:51], s69 offen nt
s_mov_b32 s67, 20
ds_read_b64 v[248:249], v5
s_waitcnt lgkmcnt(0)
v_max_u32 v250, v248, v249
v_cmp_eq_u32 s[98:99], -1, v250
s_cmp_eq_u64 s[98:99], 0
s_cbranch_scc1 L_pv
s_waitcnt vmcnt(11)
s_add_u32 s69, s65, 229376
buffer_load_dwordx4 v[88:91], v2, s[48:51], s69 offen nt
s_mov_b32 s67, 21
ds_read_b64 v[248:249], v5
s_waitcnt lgkmcnt(0)
v_max_u32 v250, v248, v249
v_cmp_eq_u32 s[98:99], -1, v250
s_cmp_eq_u64 s[98:99], 0
s_cbranch_scc1 L_pv
s_waitcnt vmcnt(11)
s_add_u32 s69, s65, 236544
buffer_load_dwordx4 v[92:95], v2, s[48:51], s69 offen nt
s_mov_b32 s67, 22
ds_read_b64 v[248:249], v5
s_waitcnt lgkmcnt(0)
v_max_u32 v250, v248, v249
v_cmp_eq_u32 s[98:99], -1, v250
s_cmp_eq_u64 s[98:99], 0
s_cbranch_scc1 L_pv
s_waitcnt vmcnt(11)
s_add_u32 s69, s65, 243712
buffer_load_dwordx4 v[96:99], v2, s[48:51], s69 offen nt
s_mov_b32 s67, 23
ds_read_b64 v[248:249], v5
s_waitcnt lgkmcnt(0)
v_max_u32 v250, v248, v249
v_cmp_eq_u32 s[98:99], -1, v250
s_cmp_eq_u64 s[98:99], 0
s_cbranch_scc1 L_pv
s_waitcnt vmcnt(11)
s_add_u32 s69, s65, 250880
buffer_load_dwordx4 v[100:103], v2, s[48:51], s69 offen nt
s_mov_b32 s67, 24
ds_read_b64 v[248:249], v5
s_waitcnt lgkmcnt(0)
v_max_u32 v250, v248, v249
v_cmp_eq_u32 s[98:99], -1, v250
s_cmp_eq_u64 s[98:99], 0
s_cbranch_scc1 L_pv
s_waitcnt vmcnt(11)
s_add_u32 s69, s65, 258048
buffer_load_dwordx4 v[104:107], v2, s[48:51], s69 offen nt
s_mov_b32 s67, 25
L_sspin:
ds_read_b64 v[248:249], v5
s_waitcnt lgkmcnt(0)
v_max_u32 v250, v248, v249
v_cmp_eq_u32 s[98:99], -1, v250
s_cmp_eq_u64 s[98:99], 0
s_cbranch_scc1 L_pv
s_sub_u32 s66, s66, 1
s_cbranch_scc0 L_sspin
s_mov_b32 s66, 0
L_pv:
s_mov_b32 s12, 0x3db8aa3b
v_sub_f32 v212, v212, v248
v_sub_f32 v213, v213, v248
v_sub_f32 v214, v214, v248
v_mul_f32 v212, s12, v212
v_mul_f32 v213, s12, v213
v_mul_f32 v214, s12, v214
v_exp_f32 v212, v212
v_exp_f32 v213, v213
v_exp_f32 v214, v214
v_mul_f32 v212, v212, v249
v_mul_f32 v213, v213, v249
v_mul_f32 v214, v214, v249
v_cvt_pk_bf16_f32 v212, v212, v212
v_cvt_pk_bf16_f32 v213, v213, v213
v_cvt_pk_bf16_f32 v214, v214, v214
s_cmp_gt_u32 s67, 10
s_cbranch_scc1 L_xsk10
s_cbranch_vccnz L_th90
s_waitcnt vmcnt(3)
L_th90:
s_add_u32 s69, s65, 172032
buffer_load_dwordx4 v[56:59], v2, s[48:51], s69 offen nt
L_xsk10:
v_and_b32_dpp v232, v212, v208 row_newbcast:0 row_mask:0xf bank_mask:0xf
v_and_b32_dpp v233, v212, v209 row_newbcast:0 row_mask:0xf bank_mask:0xf
v_and_b32_dpp v234, v212, v210 row_newbcast:0 row_mask:0xf bank_mask:0xf
v_and_b32_dpp v235, v212, v211 row_newbcast:0 row_mask:0xf bank_mask:0xf
s_nop 1
v_mfma_f32_32x32x16_bf16 v[216:231], v[232:235], v[156:159], 0
v_and_b32_dpp v236, v212, v208 row_newbcast:8 row_mask:0xf bank_mask:0xf
v_and_b32_dpp v237, v212, v209 row_newbcast:8 row_mask:0xf bank_mask:0xf
v_and_b32_dpp v238, v212, v210 row_newbcast:8 row_mask:0xf bank_mask:0xf
v_and_b32_dpp v239, v212, v211 row_newbcast:8 row_mask:0xf bank_mask:0xf
s_nop 1
v_mfma_f32_32x32x16_bf16 v[216:231], v[236:239], v[160:163], v[216:231]
v_and_b32_dpp v232, v212, v208 row_newbcast:4 row_mask:0xf bank_mask:0xf
v_and_b32_dpp v233, v212, v209 row_newbcast:4 row_mask:0xf bank_mask:0xf
v_and_b32_dpp v234, v212, v210 row_newbcast:4 row_mask:0xf bank_mask:0xf
v_and_b32_dpp v235, v212, v211 row_newbcast:4 row_mask:0xf bank_mask:0xf
s_nop 1
v_mfma_f32_32x32x16_bf16 v[216:231], v[232:235], v[164:167], v[216:231]
s_cmp_gt_u32 s67, 11
s_cbranch_scc1 L_xsk11
s_cbranch_vccnz L_th91
s_waitcnt vmcnt(3)
L_th91:
s_add_u32 m0, s64, 2048
s_mov_b32 s69, 14336
buffer_load_dwordx4 v253, s[60:63], s69 offen nt lds
L_xsk11:
v_and_b32_dpp v236, v212, v208 row_newbcast:12 row_mask:0xf bank_mask:0xf
v_and_b32_dpp v237, v212, v209 row_newbcast:12 row_mask:0xf bank_mask:0xf
v_and_b32_dpp v238, v212, v210 row_newbcast:12 row_mask:0xf bank_mask:0xf
v_and_b32_dpp v239, v212, v211 row_newbcast:12 row_mask:0xf bank_mask:0xf
s_nop 1
v_mfma_f32_32x32x16_bf16 v[216:231], v[236:239], v[168:171], v[216:231]
v_and_b32_dpp v232, v212, v208 row_newbcast:1 row_mask:0xf bank_mask:0xf
v_and_b32_dpp v233, v212, v209 row_newbcast:1 row_mask:0xf bank_mask:0xf
v_and_b32_dpp v234, v212, v210 row_newbcast:1 row_mask:0xf bank_mask:0xf
v_and_b32_dpp v235, v212, v211 row_newbcast:1 row_mask:0xf bank_mask:0xf
s_nop 1
v_mfma_f32_32x32x16_bf16 v[216:231], v[232:235], v[172:175], v[216:231]
v_and_b32_dpp v236, v212, v208 row_newbcast:9 row_mask:0xf bank_mask:0xf
v_and_b32_dpp v237, v212, v209 row_newbcast:9 row_mask:0xf bank_mask:0xf
v_and_b32_dpp v238, v212, v210 row_newbcast:9 row_mask:0xf bank_mask:0xf
v_and_b32_dpp v239, v212, v211 row_newbcast:9 row_mask:0xf bank_mask:0xf
s_nop 1
v_mfma_f32_32x32x16_bf16 v[216:231], v[236:239], v[176:179], v[216:231]
s_cmp_gt_u32 s67, 12
s_cbranch_scc1 L_xsk12
s_cbranch_vccnz L_th92
s_waitcnt vmcnt(3)
L_th92:
s_add_u32 s69, s65, 179200
buffer_load_dwordx4 v[60:63], v2, s[48:51], s69 offen nt
L_xsk12:
v_and_b32_dpp v232, v212, v208 row_newbcast:5 row_mask:0xf bank_mask:0xf
v_and_b32_dpp v233, v212, v209 row_newbcast:5 row_mask:0xf bank_mask:0xf
v_and_b32_dpp v234, v212, v210 row_newbcast:5 row_mask:0xf bank_mask:0xf
v_and_b32_dpp v235, v212, v211 row_newbcast:5 row_mask:0xf bank_mask:0xf
s_nop 1
v_mfma_f32_32x32x16_bf16 v[216:231], v[232:235], v[180:183], v[216:231]
v_and_b32_dpp v236, v212, v208 row_newbcast:13 row_mask:0xf bank_mask:0xf
v_and_b32_dpp v237, v212, v209 row_newbcast:13 row_mask:0xf bank_mask:0xf
v_and_b32_dpp v238, v212, v210 row_newbcast:13 row_mask:0xf bank_mask:0xf
v_and_b32_dpp v239, v212, v211 row_newbcast:13 row_mask:0xf bank_mask:0xf
s_nop 1
v_mfma_f32_32x32x16_bf16 v[216:231], v[236:239], v[184:187], v[216:231]
v_and_b32_dpp v232, v212, v208 row_newbcast:2 row_mask:0xf bank_mask:0xf
v_and_b32_dpp v233, v212, v209 row_newbcast:2 row_mask:0xf bank_mask:0xf
v_and_b32_dpp v234, v212, v210 row_newbcast:2 row_mask:0xf bank_mask:0xf
v_and_b32_dpp v235, v212, v211 row_newbcast:2 row_mask:0xf bank_mask:0xf
s_nop 1
v_mfma_f32_32x32x16_bf16 v[216:231], v[232:235], v[188:191], v[216:231]
s_cmp_gt_u32 s67, 13
s_cbranch_scc1 L_xsk13
s_cbranch_vccnz L_th93
s_waitcnt vmcnt(3)
L_th93:
s_add_u32 s69, s65, 186368
buffer_load_dwordx4 v[64:67], v2, s[48:51], s69 offen nt
L_xsk13:
v_and_b32_dpp v236, v212, v208 row_newbcast:10 row_mask:0xf bank_mask:0xf
v_and_b32_dpp v237, v212, v209 row_newbcast:10 row_mask:0xf bank_mask:0xf
v_and_b32_dpp v238, v212, v210 row_newbcast:10 row_mask:0xf bank_mask:0xf
v_and_b32_dpp v239, v212, v211 row_newbcast:10 row_mask:0xf bank_mask:0xf
s_nop 1
v_mfma_f32_32x32x16_bf16 v[216:231], v[236:239], v[192:195], v[216:231]
v_and_b32_dpp v232, v212, v208 row_newbcast:6 row_mask:0xf bank_mask:0xf
v_and_b32_dpp v233, v212, v209 row_newbcast:6 row_mask:0xf bank_mask:0xf
v_and_b32_dpp v234, v212, v210 row_newbcast:6 row_mask:0xf bank_mask:0xf
v_and_b32_dpp v235, v212, v211 row_newbcast:6 row_mask:0xf bank_mask:0xf
s_nop 1
v_mfma_f32_32x32x16_bf16 v[216:231], v[232:235], v[196:199], v[216:231]
v_and_b32_dpp v236, v212, v208 row_newbcast:14 row_mask:0xf bank_mask:0xf
v_and_b32_dpp v237, v212, v209 row_newbcast:14 row_mask:0xf bank_mask:0xf
v_and_b32_dpp v238, v212, v210 row_newbcast:14 row_mask:0xf bank_mask:0xf
v_and_b32_dpp v239, v212, v211 row_newbcast:14 row_mask:0xf bank_mask:0xf
s_nop 1
v_mfma_f32_32x32x16_bf16 v[216:231], v[236:239], v[200:203], v[216:231]
s_cmp_gt_u32 s67, 14
s_cbranch_scc1 L_xsk14
s_cbranch_vccnz L_th94
s_waitcnt vmcnt(3)
L_th94:
s_waitcnt vmcnt(11)
s_add_u32 s69, s65, 193536
buffer_load_dwordx4 v[68:71], v2, s[48:51], s69 offen nt
L_xsk14:
v_and_b32_dpp v232, v212, v208 row_newbcast:3 row_mask:0xf bank_mask:0xf
v_and_b32_dpp v233, v212, v209 row_newbcast:3 row_mask:0xf bank_mask:0xf
v_and_b32_dpp v234, v212, v210 row_newbcast:3 row_mask:0xf bank_mask:0xf
v_and_b32_dpp v235, v212, v211 row_newbcast:3 row_mask:0xf bank_mask:0xf
s_nop 1
v_mfma_f32_32x32x16_bf16 v[216:231], v[232:235], v[8:11], v[216:231]
v_and_b32_dpp v236, v212, v208 row_newbcast:11 row_mask:0xf bank_mask:0xf
v_and_b32_dpp v237, v212, v209 row_newbcast:11 row_mask:0xf bank_mask:0xf
v_and_b32_dpp v238, v212, v210 row_newbcast:11 row_mask:0xf bank_mask:0xf
v_and_b32_dpp v239, v212, v211 row_newbcast:11 row_mask:0xf bank_mask:0xf
s_nop 1
v_mfma_f32_32x32x16_bf16 v[216:231], v[236:239], v[12:15], v[216:231]
v_and_b32_dpp v232, v212, v208 row_newbcast:7 row_mask:0xf bank_mask:0xf
v_and_b32_dpp v233, v212, v209 row_newbcast:7 row_mask:0xf bank_mask:0xf
v_and_b32_dpp v234, v212, v210 row_newbcast:7 row_mask:0xf bank_mask:0xf
v_and_b32_dpp v235, v212, v211 row_newbcast:7 row_mask:0xf bank_mask:0xf
s_nop 1
v_mfma_f32_32x32x16_bf16 v[216:231], v[232:235], v[16:19], v[216:231]
s_cmp_gt_u32 s67, 15
s_cbranch_scc1 L_xsk15
s_cbranch_vccnz L_th95
s_waitcnt vmcnt(3)
L_th95:
s_waitcnt vmcnt(11)
s_add_u32 m0, s64, 3072
s_mov_b32 s69, 21504
buffer_load_dwordx4 v252, s[60:63], s69 offen nt lds
L_xsk15:
v_and_b32_dpp v236, v212, v208 row_newbcast:15 row_mask:0xf bank_mask:0xf
v_and_b32_dpp v237, v212, v209 row_newbcast:15 row_mask:0xf bank_mask:0xf
v_and_b32_dpp v238, v212, v210 row_newbcast:15 row_mask:0xf bank_mask:0xf
v_and_b32_dpp v239, v212, v211 row_newbcast:15 row_mask:0xf bank_mask:0xf
s_nop 1
v_mfma_f32_32x32x16_bf16 v[216:231], v[236:239], v[20:23], v[216:231]
v_and_b32_dpp v232, v213, v208 row_newbcast:0 row_mask:0xf bank_mask:0xf
v_and_b32_dpp v233, v213, v209 row_newbcast:0 row_mask:0xf bank_mask:0xf
v_and_b32_dpp v234, v213, v210 row_newbcast:0 row_mask:0xf bank_mask:0xf
v_and_b32_dpp v235, v213, v211 row_newbcast:0 row_mask:0xf bank_mask:0xf
s_nop 1
v_mfma_f32_32x32x16_bf16 v[216:231], v[232:235], v[24:27], v[216:231]
ds_read_b64_tr_b16 v[156:157], v124 offset:0
ds_read_b64_tr_b16 v[158:159], v124 offset:512
ds_read_b64_tr_b16 v[160:161], v125 offset:0
ds_read_b64_tr_b16 v[162:163], v125 offset:512
ds_read_b64_tr_b16 v[164:165], v126 offset:0
ds_read_b64_tr_b16 v[166:167], v126 offset:512
ds_read_b64_tr_b16 v[168:169], v127 offset:0
ds_read_b64_tr_b16 v[170:171], v127 offset:512
ds_read_b64_tr_b16 v[172:173], v126 offset:1024
ds_read_b64_tr_b16 v[174:175], v126 offset:1536
ds_read_b64_tr_b16 v[176:177], v127 offset:1024
ds_read_b64_tr_b16 v[178:179], v127 offset:1536
ds_read_b64_tr_b16 v[180:181], v124 offset:1024
ds_read_b64_tr_b16 v[182:183], v124 offset:1536
ds_read_b64_tr_b16 v[184:185], v125 offset:1024
ds_read_b64_tr_b16 v[186:187], v125 offset:1536
v_and_b32_dpp v236, v213, v208 row_newbcast:8 row_mask:0xf bank_mask:0xf
v_and_b32_dpp v237, v213, v209 row_newbcast:8 row_mask:0xf bank_mask:0xf
v_and_b32_dpp v238, v213, v210 row_newbcast:8 row_mask:0xf bank_mask:0xf
v_and_b32_dpp v239, v213, v211 row_newbcast:8 row_mask:0xf bank_mask:0xf
s_nop 1
v_mfma_f32_32x32x16_bf16 v[216:231], v[236:239], v[28:31], v[216:231]
s_cmp_gt_u32 s67, 16
s_cbranch_scc1 L_xsk16
s_waitcnt vmcnt(11)
s_add_u32 s69, s65, 200704
buffer_load_dwordx4 v[72:75], v2, s[48:51], s69 offen nt
L_xsk16:
v_and_b32_dpp v232, v213, v208 row_newbcast:4 row_mask:0xf bank_mask:0xf
v_and_b32_dpp v233, v213, v209 row_newbcast:4 row_mask:0xf bank_mask:0xf
v_and_b32_dpp v234, v213, v210 row_newbcast:4 row_mask:0xf bank_mask:0xf
v_and_b32_dpp v235, v213, v211 row_newbcast:4 row_mask:0xf bank_mask:0xf
s_nop 1
v_mfma_f32_32x32x16_bf16 v[216:231], v[232:235], v[32:35], v[216:231]
ds_read_b64_tr_b16 v[188:189], v128 offset:0
ds_read_b64_tr_b16 v[190:191], v128 offset:1024
ds_read_b64_tr_b16 v[192:193], v129 offset:0
ds_read_b64_tr_b16 v[194:195], v129 offset:1024
ds_read_b64_tr_b16 v[196:197], v128 offset:64
ds_read_b64_tr_b16 v[198:199], v128 offset:1088
ds_read_b64_tr_b16 v[200:201], v129 offset:64
ds_read_b64_tr_b16 v[202:203], v129 offset:1088
v_and_b32_dpp v236, v213, v208 row_newbcast:12 row_mask:0xf bank_mask:0xf
v_and_b32_dpp v237, v213, v209 row_newbcast:12 row_mask:0xf bank_mask:0xf
v_and_b32_dpp v238, v213, v210 row_newbcast:12 row_mask:0xf bank_mask:0xf
v_and_b32_dpp v239, v213, v211 row_newbcast:12 row_mask:0xf bank_mask:0xf
s_nop 1
v_mfma_f32_32x32x16_bf16 v[216:231], v[236:239], v[36:39], v[216:231]
s_cmp_gt_u32 s67, 17
s_cbranch_scc1 L_xsk17
s_waitcnt vmcnt(11)
s_add_u32 s69, s65, 207872
buffer_load_dwordx4 v[76:79], v2, s[48:51], s69 offen nt
L_xsk17:
v_and_b32_dpp v232, v213, v208 row_newbcast:1 row_mask:0xf bank_mask:0xf
v_and_b32_dpp v233, v213, v209 row_newbcast:1 row_mask:0xf bank_mask:0xf
v_and_b32_dpp v234, v213, v210 row_newbcast:1 row_mask:0xf bank_mask:0xf
v_and_b32_dpp v235, v213, v211 row_newbcast:1 row_mask:0xf bank_mask:0xf
s_nop 1
v_mfma_f32_32x32x16_bf16 v[216:231], v[232:235], v[40:43], v[216:231]
s_cmp_gt_u32 s67, 18
s_cbranch_scc1 L_xsk18
s_waitcnt vmcnt(11)
s_add_u32 s69, s65, 215040
buffer_load_dwordx4 v[80:83], v2, s[48:51], s69 offen nt
L_xsk18:
s_cmp_gt_u32 s67, 19
s_cbranch_scc1 L_xsk19
s_waitcnt vmcnt(11)
s_add_u32 s69, s65, 222208
buffer_load_dwordx4 v[84:87], v2, s[48:51], s69 offen nt
L_xsk19:
v_and_b32_dpp v236, v213, v208 row_newbcast:9 row_mask:0xf bank_mask:0xf
v_and_b32_dpp v237, v213, v209 row_newbcast:9 row_mask:0xf bank_mask:0xf
v_and_b32_dpp v238, v213, v210 row_newbcast:9 row_mask:0xf bank_mask:0xf
v_and_b32_dpp v239, v213, v211 row_newbcast:9 row_mask:0xf bank_mask:0xf
s_nop 1
v_mfma_f32_32x32x16_bf16 v[216:231], v[236:239], v[44:47], v[216:231]
s_cmp_gt_u32 s67, 20
s_cbranch_scc1 L_xsk20
s_waitcnt vmcnt(11)
s_add_u32 s69, s65, 229376
buffer_load_dwordx4 v[88:91], v2, s[48:51], s69 offen nt
L_xsk20:
v_and_b32_dpp v232, v213, v208 row_newbcast:5 row_mask:0xf bank_mask:0xf
v_and_b32_dpp v233, v213, v209 row_newbcast:5 row_mask:0xf bank_mask:0xf
v_and_b32_dpp v234, v213, v210 row_newbcast:5 row_mask:0xf bank_mask:0xf
v_and_b32_dpp v235, v213, v211 row_newbcast:5 row_mask:0xf bank_mask:0xf
s_nop 1
v_mfma_f32_32x32x16_bf16 v[216:231], v[232:235], v[48:51], v[216:231]
s_cmp_gt_u32 s67, 21
s_cbranch_scc1 L_xsk21
s_waitcnt vmcnt(11)
s_add_u32 s69, s65, 236544
buffer_load_dwordx4 v[92:95], v2, s[48:51], s69 offen nt
L_xsk21:
v_and_b32_dpp v236, v213, v208 row_newbcast:13 row_mask:0xf bank_mask:0xf
v_and_b32_dpp v237, v213, v209 row_newbcast:13 row_mask:0xf bank_mask:0xf
v_and_b32_dpp v238, v213, v210 row_newbcast:13 row_mask:0xf bank_mask:0xf
v_and_b32_dpp v239, v213, v211 row_newbcast:13 row_mask:0xf bank_mask:0xf
s_nop 1
v_mfma_f32_32x32x16_bf16 v[216:231], v[236:239], v[52:55], v[216:231]
s_cmp_gt_u32 s67, 22
s_cbranch_scc1 L_xsk22
s_waitcnt vmcnt(11)
s_add_u32 s69, s65, 243712
buffer_load_dwordx4 v[96:99], v2, s[48:51], s69 offen nt
L_xsk22:
v_and_b32_dpp v232, v213, v208 row_newbcast:2 row_mask:0xf bank_mask:0xf
v_and_b32_dpp v233, v213, v209 row_newbcast:2 row_mask:0xf bank_mask:0xf
v_and_b32_dpp v234, v213, v210 row_newbcast:2 row_mask:0xf bank_mask:0xf
v_and_b32_dpp v235, v213, v211 row_newbcast:2 row_mask:0xf bank_mask:0xf
s_nop 1
v_mfma_f32_32x32x16_bf16 v[216:231], v[232:235], v[56:59], v[216:231]
s_cmp_gt_u32 s67, 23
s_cbranch_scc1 L_xsk23
s_waitcnt vmcnt(11)
s_add_u32 s69, s65, 250880
buffer_load_dwordx4 v[100:103], v2, s[48:51], s69 offen nt
L_xsk23:
s_cmp_gt_u32 s67, 24
s_cbranch_scc1 L_xsk24
s_waitcnt vmcnt(11)
s_add_u32 s69, s65, 258048
buffer_load_dwordx4 v[104:107], v2, s[48:51], s69 offen nt
L_xsk24:
v_and_b32_dpp v236, v213, v208 row_newbcast:10 row_mask:0xf bank_mask:0xf
v_and_b32_dpp v237, v213, v209 row_newbcast:10 row_mask:0xf bank_mask:0xf
v_and_b32_dpp v238, v213, v210 row_newbcast:10 row_mask:0xf bank_mask:0xf
v_and_b32_dpp v239, v213, v211 row_newbcast:10 row_mask:0xf bank_mask:0xf
s_nop 1
v_mfma_f32_32x32x16_bf16 v[216:231], v[236:239], v[60:63], v[216:231]
v_and_b32_dpp v232, v213, v208 row_newbcast:6 row_mask:0xf bank_mask:0xf
v_and_b32_dpp v233, v213, v209 row_newbcast:6 row_mask:0xf bank_mask:0xf
v_and_b32_dpp v234, v213, v210 row_newbcast:6 row_mask:0xf bank_mask:0xf
v_and_b32_dpp v235, v213, v211 row_newbcast:6 row_mask:0xf bank_mask:0xf
s_waitcnt vmcnt(11)
s_nop 0
v_mfma_f32_32x32x16_bf16 v[216:231], v[232:235], v[64:67], v[216:231]
v_and_b32_dpp v236, v213, v208 row_newbcast:14 row_mask:0xf bank_mask:0xf
v_and_b32_dpp v237, v213, v209 row_newbcast:14 row_mask:0xf bank_mask:0xf
v_and_b32_dpp v238, v213, v210 row_newbcast:14 row_mask:0xf bank_mask:0xf
v_and_b32_dpp v239, v213, v211 row_newbcast:14 row_mask:0xf bank_mask:0xf
s_waitcnt vmcnt(10)
s_nop 0
v_mfma_f32_32x32x16_bf16 v[216:231], v[236:239], v[68:71], v[216:231]
v_and_b32_dpp v232, v213, v208 row_newbcast:3 row_mask:0xf bank_mask:0xf
v_and_b32_dpp v233, v213, v209 row_newbcast:3 row_mask:0xf bank_mask:0xf
v_and_b32_dpp v234, v213, v210 row_newbcast:3 row_mask:0xf bank_mask:0xf
v_and_b32_dpp v235, v213, v211 row_newbcast:3 row_mask:0xf bank_mask:0xf
s_waitcnt vmcnt(8)
s_nop 0
v_mfma_f32_32x32x16_bf16 v[216:231], v[232:235], v[72:75], v[216:231]
ds_read_b64_tr_b16 v[108:109], v152 offset:0
ds_read_b64_tr_b16 v[110:111], v152 offset:512
ds_read_b64_tr_b16 v[112:113], v152 offset:8
ds_read_b64_tr_b16 v[114:115], v152 offset:520
ds_read_b64_tr_b16 v[116:117], v152 offset:16
ds_read_b64_tr_b16 v[118:119], v152 offset:528
ds_read_b64_tr_b16 v[120:121], v152 offset:24
ds_read_b64_tr_b16 v[122:123], v152 offset:536
v_and_b32_dpp v236, v213, v208 row_newbcast:11 row_mask:0xf bank_mask:0xf
v_and_b32_dpp v237, v213, v209 row_newbcast:11 row_mask:0xf bank_mask:0xf
v_and_b32_dpp v238, v213, v210 row_newbcast:11 row_mask:0xf bank_mask:0xf
v_and_b32_dpp v239, v213, v211 row_newbcast:11 row_mask:0xf bank_mask:0xf
s_waitcnt vmcnt(7)
s_nop 0
v_mfma_f32_32x32x16_bf16 v[216:231], v[236:239], v[76:79], v[216:231]
v_and_b32_dpp v232, v213, v208 row_newbcast:7 row_mask:0xf bank_mask:0xf
v_and_b32_dpp v233, v213, v209 row_newbcast:7 row_mask:0xf bank_mask:0xf
v_and_b32_dpp v234, v213, v210 row_newbcast:7 row_mask:0xf bank_mask:0xf
v_and_b32_dpp v235, v213, v211 row_newbcast:7 row_mask:0xf bank_mask:0xf
s_waitcnt vmcnt(6)
s_nop 0
v_mfma_f32_32x32x16_bf16 v[216:231], v[232:235], v[80:83], v[216:231]
v_and_b32_dpp v236, v213, v208 row_newbcast:15 row_mask:0xf bank_mask:0xf
v_and_b32_dpp v237, v213, v209 row_newbcast:15 row_mask:0xf bank_mask:0xf
v_and_b32_dpp v238, v213, v210 row_newbcast:15 row_mask:0xf bank_mask:0xf
v_and_b32_dpp v239, v213, v211 row_newbcast:15 row_mask:0xf bank_mask:0xf
s_waitcnt vmcnt(5)
s_nop 0
v_mfma_f32_32x32x16_bf16 v[216:231], v[236:239], v[84:87], v[216:231]
v_and_b32_dpp v232, v214, v208 row_newbcast:0 row_mask:0xf bank_mask:0xf
v_and_b32_dpp v233, v214, v209 row_newbcast:0 row_mask:0xf bank_mask:0xf
v_and_b32_dpp v234, v214, v210 row_newbcast:0 row_mask:0xf bank_mask:0xf
v_and_b32_dpp v235, v214, v211 row_newbcast:0 row_mask:0xf bank_mask:0xf
s_waitcnt vmcnt(4)
s_nop 0
v_mfma_f32_32x32x16_bf16 v[216:231], v[232:235], v[88:91], v[216:231]
v_and_b32_dpp v236, v214, v208 row_newbcast:8 row_mask:0xf bank_mask:0xf
v_and_b32_dpp v237, v214, v209 row_newbcast:8 row_mask:0xf bank_mask:0xf
v_and_b32_dpp v238, v214, v210 row_newbcast:8 row_mask:0xf bank_mask:0xf
v_and_b32_dpp v239, v214, v211 row_newbcast:8 row_mask:0xf bank_mask:0xf
s_waitcnt vmcnt(3)
s_nop 0
v_mfma_f32_32x32x16_bf16 v[216:231], v[236:239], v[92:95], v[216:231]
v_and_b32_dpp v232, v214, v208 row_newbcast:4 row_mask:0xf bank_mask:0xf
v_and_b32_dpp v233, v214, v209 row_newbcast:4 row_mask:0xf bank_mask:0xf
v_and_b32_dpp v234, v214, v210 row_newbcast:4 row_mask:0xf bank_mask:0xf
v_and_b32_dpp v235, v214, v211 row_newbcast:4 row_mask:0xf bank_mask:0xf
s_waitcnt vmcnt(2)
s_nop 0
v_mfma_f32_32x32x16_bf16 v[216:231], v[232:235], v[96:99], v[216:231]
v_and_b32_dpp v236, v214, v208 row_newbcast:12 row_mask:0xf bank_mask:0xf
v_and_b32_dpp v237, v214, v209 row_newbcast:12 row_mask:0xf bank_mask:0xf
v_and_b32_dpp v238, v214, v210 row_newbcast:12 row_mask:0xf bank_mask:0xf
v_and_b32_dpp v239, v214, v211 row_newbcast:12 row_mask:0xf bank_mask:0xf
s_waitcnt vmcnt(1)
s_nop 0
v_mfma_f32_32x32x16_bf16 v[216:231], v[236:239], v[100:103], v[216:231]
v_mov_b32 v12, 0
v_mov_b32 v13, 0
v_mov_b32 v14, 0
v_mov_b32 v15, 0
v_and_b32_dpp v232, v214, v208 row_newbcast:1 row_mask:0xf bank_mask:0xf
v_and_b32_dpp v233, v214, v209 row_newbcast:1 row_mask:0xf bank_mask:0xf
v_and_b32_dpp v234, v214, v210 row_newbcast:1 row_mask:0xf bank_mask:0xf
v_and_b32_dpp v235, v214, v211 row_newbcast:1 row_mask:0xf bank_mask:0xf
s_waitcnt vmcnt(0)
s_nop 0
v_mfma_f32_32x32x16_bf16 v[216:231], v[232:235], v[104:107], v[216:231]
s_nop 11
ds_write_b128 v133, v[216:219]
ds_write_b128 v133, v[224:227] offset:1024
s_branch L_tail2
L_service:
v_lshrrev_b32 v11, 4, v0
v_and_b32 v12, 15, v0
v_mov_b32 v17, 0
v_mov_b32 v18, 1
s_getreg_b32 s14, hwreg(HW_REG_XCC_ID)
s_and_b32 s8, s14, 0x7fffffff
s_lshl_b32 s12, s9, 7
s_lshl_b32 s13, s7, 4
s_add_u32 s12, s12, s13
s_add_u32 s12, s12, 7168
v_mov_b32 v27, s12
v_mov_b32 v252, s8
v_mov_b32 v253, 0
v_mov_b32 v254, 0
v_mov_b32 v255, 0
s_lshl_b32 s12, s4, 9
s_add_u32 s12, s12, 7168
v_and_b32 v29, 31, v0
v_lshlrev_b32 v29, 4, v29
v_add_u32 v29, s12, v29
v_and_b32 v21, 7, v0
v_min_u32 v21, 6, v21
v_lshlrev_b32 v21, 2, v21
v_add_u32 v21, 156192, v21
s_cmp_lt_u32 s5, 42
s_cbranch_scc1 L_mrole
s_cmp_ge_u32 s2, 224
s_cbranch_scc1 L_qrole
s_waitcnt lgkmcnt(0)
s_cmp_eq_u32 s2, 162
s_cbranch_scc0 L_nota
s_waitcnt vmcnt(0)
s_mov_b32 exec_lo, 1
s_mov_b32 exec_hi, 0
global_store_dword v17, v18, s[38:39] offset:128 sc1
s_mov_b64 exec, -1
s_branch L_common2
L_nota:
s_cmp_lt_u32 s2, 64
s_cbranch_scc1 L_common
s_cmp_lt_u32 s2, 128
s_cbranch_scc0 L_noclr
s_sub_u32 s12, s2, 64
s_mul_i32 s12, s12, 17408
s_add_u32 s12, s12, 65536
v_add_u32 v20, s12, v2
global_store_dwordx4 v20, v[4:7], s[40:41] offset:0 sc1
global_store_dwordx4 v20, v[4:7], s[40:41] offset:1024 sc1
global_store_dwordx4 v20, v[4:7], s[40:41] offset:2048 sc1
global_store_dwordx4 v20, v[4:7], s[40:41] offset:3072 sc1
v_add_u32 v20, 4096, v20
global_store_dwordx4 v20, v[4:7], s[40:41] offset:0 sc1
global_store_dwordx4 v20, v[4:7], s[40:41] offset:1024 sc1
global_store_dwordx4 v20, v[4:7], s[40:41] offset:2048 sc1
global_store_dwordx4 v20, v[4:7], s[40:41] offset:3072 sc1
v_add_u32 v20, 4096, v20
global_store_dwordx4 v20, v[4:7], s[40:41] offset:0 sc1
global_store_dwordx4 v20, v[4:7], s[40:41] offset:1024 sc1
global_store_dwordx4 v20, v[4:7], s[40:41] offset:2048 sc1
global_store_dwordx4 v20, v[4:7], s[40:41] offset:3072 sc1
v_add_u32 v20, 4096, v20
global_store_dwordx4 v20, v[4:7], s[40:41] offset:0 sc1
global_store_dwordx4 v20, v[4:7], s[40:41] offset:1024 sc1
global_store_dwordx4 v20, v[4:7], s[40:41] offset:2048 sc1
global_store_dwordx4 v20, v[4:7], s[40:41] offset:3072 sc1
v_add_u32 v20, 4096, v20
global_store_dwordx4 v20, v[4:7], s[40:41] offset:0 sc1
s_waitcnt vmcnt(0)
s_mov_b32 exec_lo, 1
s_mov_b32 exec_hi, 0
global_atomic_add v98, v17, v18, s[38:39] sc0 sc1
global_load_dword v99, v17, s[38:39] offset:128 sc1
s_waitcnt vmcnt(1)
v_readfirstlane_b32 s12, v98
s_cmp_eq_u32 s12, 63
s_cbranch_scc0 L_notlast
global_store_dword v17, v18, s[38:39] offset:132 sc1
L_notlast:
s_mov_b64 exec, -1
s_branch L_flc_w
L_noclr:
s_cmp_lt_u32 s2, 160
s_cbranch_scc0 L_common
s_getpc_b64 s[64:65]
L_pcb:
s_sub_u32 s64, s64, L_pcb-adaLN_cond__gqa_block_cached__dense_activation_relu__decode_kernel
s_subb_u32 s65, s65, 0
s_lshr_b32 s12, s2, 3
s_sub_u32 s12, s12, 16
s_lshl_b32 s12, s12, 13
v_lshlrev_b32 v20, 7, v0
v_add_u32 v20, s12, v20
v_min_u32 v20, L_code_end-adaLN_cond__gqa_block_cached__dense_activation_relu__decode_kernel-4, v20
global_load_dword v20, v20, s[64:65]
s_branch L_common
L_mrole:
v_bfe_u32 v13, v0, 2, 2
v_lshrrev_b32 v14, 1, v13
v_and_b32 v15, 1, v11
v_lshl_or_b32 v14, v15, 1, v14
v_lshl_add_u32 v13, v11, 3, v13
v_lshlrev_b32 v13, 7, v13
v_lshl_add_u32 v13, v8, 3, v13
v_add_u32 v13, 94208, v13
v_xor_b32 v16, 0, v14
v_lshl_add_u32 v22, v16, 5, v13
v_xor_b32 v16, 1, v14
v_lshl_add_u32 v23, v16, 5, v13
v_xor_b32 v16, 2, v14
v_lshl_add_u32 v24, v16, 5, v13
v_xor_b32 v16, 3, v14
v_lshl_add_u32 v25, v16, 5, v13
v_bfe_u32 v26, v0, 2, 1
v_lshlrev_b32 v26, 6, v26
v_lshl_add_u32 v26, v15, 5, v26
v_lshrrev_b32 v16, 1, v11
v_lshl_add_u32 v26, v16, 4, v26
s_lshl_b32 s13, s5, 7
s_mov_b32 s14, 3584
s_mov_b32 s15, 1112320
s_cmp_lt_u32 s5, 14
s_cselect_b32 s14, 1792, s14
s_cselect_b32 s15, 0, s15
s_add_u32 s15, s15, s13
s_cmp_lt_u32 s5, 14
s_cselect_b32 s14, 16, s14
s_cselect_b32 s12, 2, 0
s_lshl_b32 s13, s5, 9
s_add_u32 s13, s13, 0
s_cmp_lt_u32 s5, 14
s_cselect_b32 s15, s13, s15
v_lshlrev_b32 v26, s12, v26
v_mul_lo_u32 v30, s14, v8
v_add_u32 v30, v26, v30
v_add_u32 v30, s15, v30
s_waitcnt lgkmcnt(0)
s_waitcnt vmcnt(0)
s_mov_b32 s14, 0xbfb8aa3b
v_add_u32 v31, 151552, v10
v_lshlrev_b32 v64, 16, v48
v_and_b32 v65, 0xffff0000, v48
v_lshlrev_b32 v66, 16, v49
v_and_b32 v67, 0xffff0000, v49
v_lshlrev_b32 v68, 16, v50
v_and_b32 v69, 0xffff0000, v50
v_lshlrev_b32 v70, 16, v51
v_and_b32 v71, 0xffff0000, v51
v_mul_f32 v72, s14, v64
v_mul_f32 v73, s14, v65
v_mul_f32 v74, s14, v66
v_mul_f32 v75, s14, v67
v_mul_f32 v76, s14, v68
v_mul_f32 v77, s14, v69
v_mul_f32 v78, s14, v70
v_mul_f32 v79, s14, v71
v_exp_f32 v72, v72
v_exp_f32 v73, v73
v_exp_f32 v74, v74
v_exp_f32 v75, v75
v_exp_f32 v76, v76
v_exp_f32 v77, v77
v_exp_f32 v78, v78
v_exp_f32 v79, v79
v_add_f32 v72, 1.0, v72
v_add_f32 v73, 1.0, v73
v_add_f32 v74, 1.0, v74
v_add_f32 v75, 1.0, v75
v_add_f32 v76, 1.0, v76
v_add_f32 v77, 1.0, v77
v_add_f32 v78, 1.0, v78
v_add_f32 v79, 1.0, v79
v_rcp_f32 v72, v72
v_rcp_f32 v73, v73
v_rcp_f32 v74, v74
v_rcp_f32 v75, v75
v_rcp_f32 v76, v76
v_rcp_f32 v77, v77
v_rcp_f32 v78, v78
v_rcp_f32 v79, v79
v_mul_f32 v72, v64, v72
v_mul_f32 v73, v65, v73
v_mul_f32 v74, v66, v74
v_mul_f32 v75, v67, v75
v_mul_f32 v76, v68, v76
v_mul_f32 v77, v69, v77
v_mul_f32 v78, v70, v78
v_mul_f32 v79, v71, v79
v_cvt_pk_bf16_f32 v48, v72, v73
v_cvt_pk_bf16_f32 v49, v74, v75
v_cvt_pk_bf16_f32 v50, v76, v77
v_cvt_pk_bf16_f32 v51, v78, v79
ds_write_b128 v31, v[48:51] offset:0
v_lshlrev_b32 v64, 16, v52
v_and_b32 v65, 0xffff0000, v52
v_lshlrev_b32 v66, 16, v53
v_and_b32 v67, 0xffff0000, v53
v_lshlrev_b32 v68, 16, v54
v_and_b32 v69, 0xffff0000, v54
v_lshlrev_b32 v70, 16, v55
v_and_b32 v71, 0xffff0000, v55
v_mul_f32 v72, s14, v64
v_mul_f32 v73, s14, v65
v_mul_f32 v74, s14, v66
v_mul_f32 v75, s14, v67
v_mul_f32 v76, s14, v68
v_mul_f32 v77, s14, v69
v_mul_f32 v78, s14, v70
v_mul_f32 v79, s14, v71
v_exp_f32 v72, v72
v_exp_f32 v73, v73
v_exp_f32 v74, v74
v_exp_f32 v75, v75
v_exp_f32 v76, v76
v_exp_f32 v77, v77
v_exp_f32 v78, v78
v_exp_f32 v79, v79
v_add_f32 v72, 1.0, v72
v_add_f32 v73, 1.0, v73
v_add_f32 v74, 1.0, v74
v_add_f32 v75, 1.0, v75
v_add_f32 v76, 1.0, v76
v_add_f32 v77, 1.0, v77
v_add_f32 v78, 1.0, v78
v_add_f32 v79, 1.0, v79
v_rcp_f32 v72, v72
v_rcp_f32 v73, v73
v_rcp_f32 v74, v74
v_rcp_f32 v75, v75
v_rcp_f32 v76, v76
v_rcp_f32 v77, v77
v_rcp_f32 v78, v78
v_rcp_f32 v79, v79
v_mul_f32 v72, v64, v72
v_mul_f32 v73, v65, v73
v_mul_f32 v74, v66, v74
v_mul_f32 v75, v67, v75
v_mul_f32 v76, v68, v76
v_mul_f32 v77, v69, v77
v_mul_f32 v78, v70, v78
v_mul_f32 v79, v71, v79
v_cvt_pk_bf16_f32 v52, v72, v73
v_cvt_pk_bf16_f32 v53, v74, v75
v_cvt_pk_bf16_f32 v54, v76, v77
v_cvt_pk_bf16_f32 v55, v78, v79
ds_write_b128 v31, v[52:55] offset:256
v_lshlrev_b32 v64, 16, v56
v_and_b32 v65, 0xffff0000, v56
v_lshlrev_b32 v66, 16, v57
v_and_b32 v67, 0xffff0000, v57
v_lshlrev_b32 v68, 16, v58
v_and_b32 v69, 0xffff0000, v58
v_lshlrev_b32 v70, 16, v59
v_and_b32 v71, 0xffff0000, v59
v_mul_f32 v72, s14, v64
v_mul_f32 v73, s14, v65
v_mul_f32 v74, s14, v66
v_mul_f32 v75, s14, v67
v_mul_f32 v76, s14, v68
v_mul_f32 v77, s14, v69
v_mul_f32 v78, s14, v70
v_mul_f32 v79, s14, v71
v_exp_f32 v72, v72
v_exp_f32 v73, v73
v_exp_f32 v74, v74
v_exp_f32 v75, v75
v_exp_f32 v76, v76
v_exp_f32 v77, v77
v_exp_f32 v78, v78
v_exp_f32 v79, v79
v_add_f32 v72, 1.0, v72
v_add_f32 v73, 1.0, v73
v_add_f32 v74, 1.0, v74
v_add_f32 v75, 1.0, v75
v_add_f32 v76, 1.0, v76
v_add_f32 v77, 1.0, v77
v_add_f32 v78, 1.0, v78
v_add_f32 v79, 1.0, v79
v_rcp_f32 v72, v72
v_rcp_f32 v73, v73
v_rcp_f32 v74, v74
v_rcp_f32 v75, v75
v_rcp_f32 v76, v76
v_rcp_f32 v77, v77
v_rcp_f32 v78, v78
v_rcp_f32 v79, v79
v_mul_f32 v72, v64, v72
v_mul_f32 v73, v65, v73
v_mul_f32 v74, v66, v74
v_mul_f32 v75, v67, v75
v_mul_f32 v76, v68, v76
v_mul_f32 v77, v69, v77
v_mul_f32 v78, v70, v78
v_mul_f32 v79, v71, v79
v_cvt_pk_bf16_f32 v56, v72, v73
v_cvt_pk_bf16_f32 v57, v74, v75
v_cvt_pk_bf16_f32 v58, v76, v77
v_cvt_pk_bf16_f32 v59, v78, v79
ds_write_b128 v31, v[56:59] offset:512
v_lshlrev_b32 v64, 16, v60
v_and_b32 v65, 0xffff0000, v60
v_lshlrev_b32 v66, 16, v61
v_and_b32 v67, 0xffff0000, v61
v_lshlrev_b32 v68, 16, v62
v_and_b32 v69, 0xffff0000, v62
v_lshlrev_b32 v70, 16, v63
v_and_b32 v71, 0xffff0000, v63
v_mul_f32 v72, s14, v64
v_mul_f32 v73, s14, v65
v_mul_f32 v74, s14, v66
v_mul_f32 v75, s14, v67
v_mul_f32 v76, s14, v68
v_mul_f32 v77, s14, v69
v_mul_f32 v78, s14, v70
v_mul_f32 v79, s14, v71
v_exp_f32 v72, v72
v_exp_f32 v73, v73
v_exp_f32 v74, v74
v_exp_f32 v75, v75
v_exp_f32 v76, v76
v_exp_f32 v77, v77
v_exp_f32 v78, v78
v_exp_f32 v79, v79
v_add_f32 v72, 1.0, v72
v_add_f32 v73, 1.0, v73
v_add_f32 v74, 1.0, v74
v_add_f32 v75, 1.0, v75
v_add_f32 v76, 1.0, v76
v_add_f32 v77, 1.0, v77
v_add_f32 v78, 1.0, v78
v_add_f32 v79, 1.0, v79
v_rcp_f32 v72, v72
v_rcp_f32 v73, v73
v_rcp_f32 v74, v74
v_rcp_f32 v75, v75
v_rcp_f32 v76, v76
v_rcp_f32 v77, v77
v_rcp_f32 v78, v78
v_rcp_f32 v79, v79
v_mul_f32 v72, v64, v72
v_mul_f32 v73, v65, v73
v_mul_f32 v74, v66, v74
v_mul_f32 v75, v67, v75
v_mul_f32 v76, v68, v76
v_mul_f32 v77, v69, v77
v_mul_f32 v78, v70, v78
v_mul_f32 v79, v71, v79
v_cvt_pk_bf16_f32 v60, v72, v73
v_cvt_pk_bf16_f32 v61, v74, v75
v_cvt_pk_bf16_f32 v62, v76, v77
v_cvt_pk_bf16_f32 v63, v78, v79
s_mov_b32 exec_lo, -1
s_mov_b32 exec_hi, 0
ds_write_b128 v31, v[60:63] offset:768
s_mov_b64 exec, -1
v_mul_u32_u24 v31, 896, v8
v_lshl_add_u32 v31, v11, 4, v31
v_add_u32 v31, 151552, v31
s_waitcnt lgkmcnt(0)
ds_read2_b64 v[100:103], v31 offset0:0 offset1:8
ds_read2_b64 v[104:107], v31 offset0:1 offset1:9
ds_read2_b64 v[108:111], v31 offset0:16 offset1:24
ds_read2_b64 v[112:115], v31 offset0:17 offset1:25
ds_read2_b64 v[116:119], v31 offset0:32 offset1:40
ds_read2_b64 v[120:123], v31 offset0:33 offset1:41
ds_read2_b64 v[124:127], v31 offset0:48 offset1:56
ds_read2_b64 v[128:131], v31 offset0:49 offset1:57
ds_read2_b64 v[132:135], v31 offset0:64 offset1:72
ds_read2_b64 v[136:139], v31 offset0:65 offset1:73
ds_read2_b64 v[140:143], v31 offset0:80 offset1:88
ds_read2_b64 v[144:147], v31 offset0:81 offset1:89
ds_read2_b64 v[148:151], v31 offset0:96 offset1:104
ds_read2_b64 v[152:155], v31 offset0:97 offset1:105
s_sub_u32 s12, s5, 7
s_cmp_lt_u32 s12, 7
s_cselect_b32 s15, 1.0, 0
s_sub_u32 s12, s5, 28
s_cmp_lt_u32 s12, 7
s_cselect_b32 s15, 1.0, s15
L_flm:
global_load_dword v99, v17, s[38:39] offset:128 sc1
L_flm_w:
s_waitcnt vmcnt(0)
v_readfirstlane_b32 s12, v99
s_cmp_lg_u32 s12, 0
s_cbranch_scc1 L_flm_done
s_sub_u32 s66, s66, 1
s_cbranch_scc0 L_flm
s_mov_b32 s66, 0
L_flm_done:
s_mov_b32 exec_lo, 1
s_mov_b32 exec_hi, 0
global_store_dwordx4 v27, v[252:255], s[40:41] sc1
s_mov_b64 exec, -1
L_swm:
s_sub_u32 s66, s66, 1
s_cbranch_scc1 L_swm_out
ds_read_b32 v98, v21
s_waitcnt lgkmcnt(0)
v_cmp_eq_u32 vcc, -1, v98
s_cbranch_vccnz L_swm
s_branch L_swm_done
L_swm_out:
s_mov_b32 s66, 0
L_swm_done:
v_and_b32 v16, 4, v0
v_cmp_ne_u32 vcc, 0, v16
ds_read_b64_tr_b16 v[156:157], v22 offset:0
ds_read_b64_tr_b16 v[158:159], v22 offset:4096
ds_read_b64_tr_b16 v[160:161], v23 offset:0
ds_read_b64_tr_b16 v[162:163], v23 offset:4096
ds_read_b64_tr_b16 v[164:165], v24 offset:0
ds_read_b64_tr_b16 v[166:167], v24 offset:4096
ds_read_b64_tr_b16 v[168:169], v25 offset:0
ds_read_b64_tr_b16 v[170:171], v25 offset:4096
ds_read_b64_tr_b16 v[172:173], v22 offset:512
ds_read_b64_tr_b16 v[174:175], v22 offset:4608
ds_read_b64_tr_b16 v[176:177], v23 offset:512
ds_read_b64_tr_b16 v[178:179], v23 offset:4608
ds_read_b64_tr_b16 v[180:181], v24 offset:512
ds_read_b64_tr_b16 v[182:183], v24 offset:4608
ds_read_b64_tr_b16 v[184:185], v25 offset:512
ds_read_b64_tr_b16 v[186:187], v25 offset:4608
ds_read_b64_tr_b16 v[188:189], v22 offset:8192
ds_read_b64_tr_b16 v[190:191], v22 offset:12288
ds_read_b64_tr_b16 v[192:193], v23 offset:8192
ds_read_b64_tr_b16 v[194:195], v23 offset:12288
ds_read_b64_tr_b16 v[196:197], v24 offset:8192
ds_read_b64_tr_b16 v[198:199], v24 offset:12288
ds_read_b64_tr_b16 v[200:201], v25 offset:8192
ds_read_b64_tr_b16 v[202:203], v25 offset:12288
ds_read_b64_tr_b16 v[204:205], v22 offset:8704
ds_read_b64_tr_b16 v[206:207], v22 offset:12800
ds_read_b64_tr_b16 v[208:209], v23 offset:8704
ds_read_b64_tr_b16 v[210:211], v23 offset:12800
ds_read_b64_tr_b16 v[212:213], v24 offset:8704
ds_read_b64_tr_b16 v[214:215], v24 offset:12800
ds_read_b64_tr_b16 v[216:217], v25 offset:8704
ds_read_b64_tr_b16 v[218:219], v25 offset:12800
ds_read_b64_tr_b16 v[220:221], v22 offset:16384
ds_read_b64_tr_b16 v[222:223], v22 offset:20480
ds_read_b64_tr_b16 v[224:225], v23 offset:16384
ds_read_b64_tr_b16 v[226:227], v23 offset:20480
ds_read_b64_tr_b16 v[228:229], v24 offset:16384
ds_read_b64_tr_b16 v[230:231], v24 offset:20480
ds_read_b64_tr_b16 v[232:233], v25 offset:16384
ds_read_b64_tr_b16 v[234:235], v25 offset:20480
ds_read_b64_tr_b16 v[236:237], v22 offset:16896
ds_read_b64_tr_b16 v[238:239], v22 offset:20992
ds_read_b64_tr_b16 v[240:241], v23 offset:16896
ds_read_b64_tr_b16 v[242:243], v23 offset:20992
ds_read_b64_tr_b16 v[244:245], v24 offset:16896
ds_read_b64_tr_b16 v[246:247], v24 offset:20992
ds_read_b64_tr_b16 v[248:249], v25 offset:16896
ds_read_b64_tr_b16 v[250:251], v25 offset:20992
s_waitcnt lgkmcnt(15)
v_mfma_f32_16x16x32_bf16 v[32:35], v[156:159], v[100:103], 0
v_mfma_f32_16x16x32_bf16 v[36:39], v[160:163], v[100:103], 0
v_mfma_f32_16x16x32_bf16 v[40:43], v[164:167], v[100:103], 0
v_mfma_f32_16x16x32_bf16 v[44:47], v[168:171], v[100:103], 0
v_mfma_f32_16x16x32_bf16 v[32:35], v[172:175], v[104:107], v[32:35]
v_mfma_f32_16x16x32_bf16 v[36:39], v[176:179], v[104:107], v[36:39]
v_mfma_f32_16x16x32_bf16 v[40:43], v[180:183], v[104:107], v[40:43]
v_mfma_f32_16x16x32_bf16 v[44:47], v[184:187], v[104:107], v[44:47]
ds_read_b64_tr_b16 v[156:157], v22 offset:24576
ds_read_b64_tr_b16 v[158:159], v22 offset:28672
ds_read_b64_tr_b16 v[160:161], v23 offset:24576
ds_read_b64_tr_b16 v[162:163], v23 offset:28672
ds_read_b64_tr_b16 v[164:165], v24 offset:24576
ds_read_b64_tr_b16 v[166:167], v24 offset:28672
ds_read_b64_tr_b16 v[168:169], v25 offset:24576
ds_read_b64_tr_b16 v[170:171], v25 offset:28672
ds_read_b64_tr_b16 v[172:173], v22 offset:25088
ds_read_b64_tr_b16 v[174:175], v22 offset:29184
ds_read_b64_tr_b16 v[176:177], v23 offset:25088
ds_read_b64_tr_b16 v[178:179], v23 offset:29184
ds_read_b64_tr_b16 v[180:181], v24 offset:25088
ds_read_b64_tr_b16 v[182:183], v24 offset:29184
ds_read_b64_tr_b16 v[184:185], v25 offset:25088
ds_read_b64_tr_b16 v[186:187], v25 offset:29184
s_waitcnt lgkmcnt(15)
v_mfma_f32_16x16x32_bf16 v[32:35], v[188:191], v[108:111], v[32:35]
v_mfma_f32_16x16x32_bf16 v[36:39], v[192:195], v[108:111], v[36:39]
v_mfma_f32_16x16x32_bf16 v[40:43], v[196:199], v[108:111], v[40:43]
v_mfma_f32_16x16x32_bf16 v[44:47], v[200:203], v[108:111], v[44:47]
v_mfma_f32_16x16x32_bf16 v[32:35], v[204:207], v[112:115], v[32:35]
v_mfma_f32_16x16x32_bf16 v[36:39], v[208:211], v[112:115], v[36:39]
v_mfma_f32_16x16x32_bf16 v[40:43], v[212:215], v[112:115], v[40:43]
v_mfma_f32_16x16x32_bf16 v[44:47], v[216:219], v[112:115], v[44:47]
ds_read_b64_tr_b16 v[188:189], v22 offset:32768
ds_read_b64_tr_b16 v[190:191], v22 offset:36864
ds_read_b64_tr_b16 v[192:193], v23 offset:32768
ds_read_b64_tr_b16 v[194:195], v23 offset:36864
ds_read_b64_tr_b16 v[196:197], v24 offset:32768
ds_read_b64_tr_b16 v[198:199], v24 offset:36864
ds_read_b64_tr_b16 v[200:201], v25 offset:32768
ds_read_b64_tr_b16 v[202:203], v25 offset:36864
ds_read_b64_tr_b16 v[204:205], v22 offset:33280
ds_read_b64_tr_b16 v[206:207], v22 offset:37376
ds_read_b64_tr_b16 v[208:209], v23 offset:33280
ds_read_b64_tr_b16 v[210:211], v23 offset:37376
ds_read_b64_tr_b16 v[212:213], v24 offset:33280
ds_read_b64_tr_b16 v[214:215], v24 offset:37376
ds_read_b64_tr_b16 v[216:217], v25 offset:33280
ds_read_b64_tr_b16 v[218:219], v25 offset:37376
s_waitcnt lgkmcnt(15)
v_mfma_f32_16x16x32_bf16 v[32:35], v[220:223], v[116:119], v[32:35]
v_mfma_f32_16x16x32_bf16 v[36:39], v[224:227], v[116:119], v[36:39]
v_mfma_f32_16x16x32_bf16 v[40:43], v[228:231], v[116:119], v[40:43]
v_mfma_f32_16x16x32_bf16 v[44:47], v[232:235], v[116:119], v[44:47]
v_mfma_f32_16x16x32_bf16 v[32:35], v[236:239], v[120:123], v[32:35]
v_mfma_f32_16x16x32_bf16 v[36:39], v[240:243], v[120:123], v[36:39]
v_mfma_f32_16x16x32_bf16 v[40:43], v[244:247], v[120:123], v[40:43]
v_mfma_f32_16x16x32_bf16 v[44:47], v[248:251], v[120:123], v[44:47]
ds_read_b64_tr_b16 v[220:221], v22 offset:40960
ds_read_b64_tr_b16 v[222:223], v22 offset:45056
ds_read_b64_tr_b16 v[224:225], v23 offset:40960
ds_read_b64_tr_b16 v[226:227], v23 offset:45056
ds_read_b64_tr_b16 v[228:229], v24 offset:40960
ds_read_b64_tr_b16 v[230:231], v24 offset:45056
ds_read_b64_tr_b16 v[232:233], v25 offset:40960
ds_read_b64_tr_b16 v[234:235], v25 offset:45056
ds_read_b64_tr_b16 v[236:237], v22 offset:41472
ds_read_b64_tr_b16 v[238:239], v22 offset:45568
ds_read_b64_tr_b16 v[240:241], v23 offset:41472
ds_read_b64_tr_b16 v[242:243], v23 offset:45568
ds_read_b64_tr_b16 v[244:245], v24 offset:41472
ds_read_b64_tr_b16 v[246:247], v24 offset:45568
ds_read_b64_tr_b16 v[248:249], v25 offset:41472
ds_read_b64_tr_b16 v[250:251], v25 offset:45568
s_waitcnt lgkmcnt(15)
v_mfma_f32_16x16x32_bf16 v[32:35], v[156:159], v[124:127], v[32:35]
v_mfma_f32_16x16x32_bf16 v[36:39], v[160:163], v[124:127], v[36:39]
v_mfma_f32_16x16x32_bf16 v[40:43], v[164:167], v[124:127], v[40:43]
v_mfma_f32_16x16x32_bf16 v[44:47], v[168:171], v[124:127], v[44:47]
v_mfma_f32_16x16x32_bf16 v[32:35], v[172:175], v[128:131], v[32:35]
v_mfma_f32_16x16x32_bf16 v[36:39], v[176:179], v[128:131], v[36:39]
v_mfma_f32_16x16x32_bf16 v[40:43], v[180:183], v[128:131], v[40:43]
v_mfma_f32_16x16x32_bf16 v[44:47], v[184:187], v[128:131], v[44:47]
ds_read_b64_tr_b16 v[156:157], v22 offset:49152
ds_read_b64_tr_b16 v[158:159], v22 offset:53248
ds_read_b64_tr_b16 v[160:161], v23 offset:49152
ds_read_b64_tr_b16 v[162:163], v23 offset:53248
ds_read_b64_tr_b16 v[164:165], v24 offset:49152
ds_read_b64_tr_b16 v[166:167], v24 offset:53248
ds_read_b64_tr_b16 v[168:169], v25 offset:49152
ds_read_b64_tr_b16 v[170:171], v25 offset:53248
ds_read_b64_tr_b16 v[172:173], v22 offset:49664
ds_read_b64_tr_b16 v[174:175], v22 offset:53760
ds_read_b64_tr_b16 v[176:177], v23 offset:49664
ds_read_b64_tr_b16 v[178:179], v23 offset:53760
ds_read_b64_tr_b16 v[180:181], v24 offset:49664
ds_read_b64_tr_b16 v[182:183], v24 offset:53760
ds_read_b64_tr_b16 v[184:185], v25 offset:49664
ds_read_b64_tr_b16 v[186:187], v25 offset:53760
s_waitcnt lgkmcnt(15)
v_mfma_f32_16x16x32_bf16 v[32:35], v[188:191], v[132:135], v[32:35]
v_mfma_f32_16x16x32_bf16 v[36:39], v[192:195], v[132:135], v[36:39]
v_mfma_f32_16x16x32_bf16 v[40:43], v[196:199], v[132:135], v[40:43]
v_mfma_f32_16x16x32_bf16 v[44:47], v[200:203], v[132:135], v[44:47]
v_mfma_f32_16x16x32_bf16 v[32:35], v[204:207], v[136:139], v[32:35]
v_mfma_f32_16x16x32_bf16 v[36:39], v[208:211], v[136:139], v[36:39]
v_mfma_f32_16x16x32_bf16 v[40:43], v[212:215], v[136:139], v[40:43]
v_mfma_f32_16x16x32_bf16 v[44:47], v[216:219], v[136:139], v[44:47]
s_waitcnt lgkmcnt(15)
v_mfma_f32_16x16x32_bf16 v[32:35], v[220:223], v[140:143], v[32:35]
v_mfma_f32_16x16x32_bf16 v[36:39], v[224:227], v[140:143], v[36:39]
v_mfma_f32_16x16x32_bf16 v[40:43], v[228:231], v[140:143], v[40:43]
v_mfma_f32_16x16x32_bf16 v[44:47], v[232:235], v[140:143], v[44:47]
v_mfma_f32_16x16x32_bf16 v[32:35], v[236:239], v[144:147], v[32:35]
v_mfma_f32_16x16x32_bf16 v[36:39], v[240:243], v[144:147], v[36:39]
v_mfma_f32_16x16x32_bf16 v[40:43], v[244:247], v[144:147], v[40:43]
v_mfma_f32_16x16x32_bf16 v[44:47], v[248:251], v[144:147], v[44:47]
s_waitcnt lgkmcnt(0)
v_mfma_f32_16x16x32_bf16 v[32:35], v[156:159], v[148:151], v[32:35]
v_mfma_f32_16x16x32_bf16 v[36:39], v[160:163], v[148:151], v[36:39]
v_mfma_f32_16x16x32_bf16 v[40:43], v[164:167], v[148:151], v[40:43]
v_mfma_f32_16x16x32_bf16 v[44:47], v[168:171], v[148:151], v[44:47]
v_mfma_f32_16x16x32_bf16 v[32:35], v[172:175], v[152:155], v[32:35]
v_mfma_f32_16x16x32_bf16 v[36:39], v[176:179], v[152:155], v[36:39]
v_mfma_f32_16x16x32_bf16 v[40:43], v[180:183], v[152:155], v[40:43]
v_mfma_f32_16x16x32_bf16 v[44:47], v[184:187], v[152:155], v[44:47]
s_nop 4
v_cvt_pk_bf16_f32 v48, v32, v33
v_cvt_pk_bf16_f32 v49, v34, v35
v_cvt_pk_bf16_f32 v50, v36, v37
v_cvt_pk_bf16_f32 v51, v38, v39
v_cvt_pk_bf16_f32 v52, v40, v41
v_cvt_pk_bf16_f32 v53, v42, v43
v_cvt_pk_bf16_f32 v54, v44, v45
v_cvt_pk_bf16_f32 v55, v46, v47
v_lshlrev_b32 v32, 16, v48
v_and_b32 v33, 0xffff0000, v48
v_lshlrev_b32 v34, 16, v49
v_and_b32 v35, 0xffff0000, v49
v_lshlrev_b32 v36, 16, v50
v_and_b32 v37, 0xffff0000, v50
v_lshlrev_b32 v38, 16, v51
v_and_b32 v39, 0xffff0000, v51
v_lshlrev_b32 v40, 16, v52
v_and_b32 v41, 0xffff0000, v52
v_lshlrev_b32 v42, 16, v53
v_and_b32 v43, 0xffff0000, v53
v_lshlrev_b32 v44, 16, v54
v_and_b32 v45, 0xffff0000, v54
v_lshlrev_b32 v46, 16, v55
v_and_b32 v47, 0xffff0000, v55
v_add_f32 v32, s15, v32
v_add_f32 v33, s15, v33
v_add_f32 v34, s15, v34
v_add_f32 v35, s15, v35
v_add_f32 v36, s15, v36
v_add_f32 v37, s15, v37
v_add_f32 v38, s15, v38
v_add_f32 v39, s15, v39
v_add_f32 v40, s15, v40
v_add_f32 v41, s15, v41
v_add_f32 v42, s15, v42
v_add_f32 v43, s15, v43
v_add_f32 v44, s15, v44
v_add_f32 v45, s15, v45
v_add_f32 v46, s15, v46
v_add_f32 v47, s15, v47
v_cvt_pk_bf16_f32 v48, v32, v33
v_cvt_pk_bf16_f32 v49, v34, v35
v_cvt_pk_bf16_f32 v50, v36, v37
v_cvt_pk_bf16_f32 v51, v38, v39
v_cvt_pk_bf16_f32 v52, v40, v41
v_cvt_pk_bf16_f32 v53, v42, v43
v_cvt_pk_bf16_f32 v54, v44, v45
v_cvt_pk_bf16_f32 v55, v46, v47
v_permlane16_swap_b32 v48, v50
v_permlane16_swap_b32 v49, v51
v_permlane16_swap_b32 v52, v54
v_permlane16_swap_b32 v53, v55
v_cndmask_b32 v56, v48, v52, vcc
v_cndmask_b32 v57, v49, v53, vcc
v_cndmask_b32 v58, v50, v54, vcc
v_cndmask_b32 v59, v51, v55, vcc
v_min_u32 v56, -2, v56
v_min_u32 v57, -2, v57
v_min_u32 v58, -2, v58
v_min_u32 v59, -2, v59
s_cmp_lt_u32 s5, 14
s_cbranch_scc1 L_m_early
L_flm2:
global_load_dword v99, v17, s[38:39] offset:132 sc1
L_flm2_w:
s_waitcnt vmcnt(0)
v_readfirstlane_b32 s12, v99
s_cmp_lg_u32 s12, 0
s_cbranch_scc1 L_flm2_done
s_sub_u32 s66, s66, 1
s_cbranch_scc0 L_flm2
s_mov_b32 s66, 0
L_flm2_done:
L_m_early:
s_mov_b32 exec_lo, 0x00ff00ff
s_mov_b32 exec_hi, 0x00ff00ff
global_store_dwordx4 v30, v[56:59], s[40:41] sc1
s_mov_b64 exec, -1
s_cmp_lt_u32 s5, 14
s_cbranch_scc1 L_fll
s_branch L_common3
L_qrole:
v_bfe_u32 v13, v0, 2, 2
v_lshrrev_b32 v14, 1, v13
v_and_b32 v15, 1, v11
v_lshl_or_b32 v14, v15, 1, v14
v_lshl_add_u32 v13, v11, 3, v13
v_lshlrev_b32 v13, 7, v13
v_lshl_add_u32 v13, v8, 3, v13
v_xor_b32 v16, 0, v14
v_lshl_add_u32 v22, v16, 5, v13
v_xor_b32 v16, 1, v14
v_lshl_add_u32 v23, v16, 5, v13
v_xor_b32 v16, 2, v14
v_lshl_add_u32 v24, v16, 5, v13
v_xor_b32 v16, 3, v14
v_lshl_add_u32 v25, v16, 5, v13
v_bfe_u32 v26, v0, 2, 1
v_lshlrev_b32 v26, 6, v26
v_lshl_add_u32 v26, v15, 5, v26
v_lshrrev_b32 v16, 1, v11
v_lshl_add_u32 v26, v16, 4, v26
s_lshl_b32 s12, s6, 8
s_lshl_b32 s13, s4, 12
s_add_u32 s13, s13, s12
s_add_u32 s13, s13, 65536
v_lshl_add_u32 v30, v8, 10, v26
v_add_u32 v30, s13, v30
s_waitcnt lgkmcnt(0)
s_waitcnt vmcnt(0)
v_add_u32 v12, 57344, v22
v_add_u32 v13, 57344, v23
v_add_u32 v14, 57344, v24
v_add_u32 v15, 57344, v25
v_lshlrev_b32 v64, 16, v48
v_and_b32 v65, 0xffff0000, v48
v_lshlrev_b32 v66, 16, v49
v_and_b32 v67, 0xffff0000, v49
v_lshlrev_b32 v68, 16, v50
v_and_b32 v69, 0xffff0000, v50
v_lshlrev_b32 v70, 16, v51
v_and_b32 v71, 0xffff0000, v51
v_lshlrev_b32 v72, 16, v52
v_and_b32 v73, 0xffff0000, v52
v_lshlrev_b32 v74, 16, v53
v_and_b32 v75, 0xffff0000, v53
v_lshlrev_b32 v76, 16, v54
v_and_b32 v77, 0xffff0000, v54
v_lshlrev_b32 v78, 16, v55
v_and_b32 v79, 0xffff0000, v55
v_lshlrev_b32 v80, 16, v56
v_and_b32 v81, 0xffff0000, v56
v_lshlrev_b32 v82, 16, v57
v_and_b32 v83, 0xffff0000, v57
v_lshlrev_b32 v84, 16, v58
v_and_b32 v85, 0xffff0000, v58
v_lshlrev_b32 v86, 16, v59
v_and_b32 v87, 0xffff0000, v59
v_lshlrev_b32 v88, 16, v60
v_and_b32 v89, 0xffff0000, v60
v_lshlrev_b32 v90, 16, v61
v_and_b32 v91, 0xffff0000, v61
v_lshlrev_b32 v92, 16, v62
v_and_b32 v93, 0xffff0000, v62
v_lshlrev_b32 v94, 16, v63
v_and_b32 v95, 0xffff0000, v63
v_add_f32 v96, v64, v65
v_add_f32 v97, v66, v67
v_add_f32 v96, v96, v68
v_add_f32 v97, v97, v69
v_add_f32 v96, v96, v70
v_add_f32 v97, v97, v71
v_add_f32 v96, v96, v72
v_add_f32 v97, v97, v73
v_add_f32 v96, v96, v74
v_add_f32 v97, v97, v75
v_add_f32 v96, v96, v76
v_add_f32 v97, v97, v77
v_add_f32 v96, v96, v78
v_add_f32 v97, v97, v79
v_add_f32 v96, v96, v80
v_add_f32 v97, v97, v81
v_add_f32 v96, v96, v82
v_add_f32 v97, v97, v83
v_add_f32 v96, v96, v84
v_add_f32 v97, v97, v85
v_add_f32 v96, v96, v86
v_add_f32 v97, v97, v87
s_mov_b32 exec_lo, -1
s_mov_b32 exec_hi, 0
v_add_f32 v96, v96, v88
v_add_f32 v97, v97, v89
v_add_f32 v96, v96, v90
v_add_f32 v97, v97, v91
v_add_f32 v96, v96, v92
v_add_f32 v97, v97, v93
v_add_f32 v96, v96, v94
v_add_f32 v97, v97, v95
s_mov_b64 exec, -1
v_add_f32 v96, v96, v97
s_nop 1
v_add_f32_dpp v96, v96, v96 row_ror:4 row_mask:0xf bank_mask:0xf
s_nop 1
v_add_f32_dpp v96, v96, v96 row_ror:8 row_mask:0xf bank_mask:0xf
v_mov_b32 v97, v96
s_nop 1
v_permlane16_swap_b32 v96, v97
v_add_f32 v96, v96, v97
v_mov_b32 v97, v96
s_nop 1
v_permlane32_swap_b32 v96, v97
v_add_f32 v96, v96, v97
v_mul_f32 v96, 0x3b124925, v96
v_sub_f32 v100, v64, v96
v_sub_f32 v101, v65, v96
v_sub_f32 v102, v66, v96
v_sub_f32 v103, v67, v96
v_sub_f32 v104, v68, v96
v_sub_f32 v105, v69, v96
v_sub_f32 v106, v70, v96
v_sub_f32 v107, v71, v96
v_sub_f32 v108, v72, v96
v_sub_f32 v109, v73, v96
v_sub_f32 v110, v74, v96
v_sub_f32 v111, v75, v96
v_sub_f32 v112, v76, v96
v_sub_f32 v113, v77, v96
v_sub_f32 v114, v78, v96
v_sub_f32 v115, v79, v96
v_sub_f32 v116, v80, v96
v_sub_f32 v117, v81, v96
v_sub_f32 v118, v82, v96
v_sub_f32 v119, v83, v96
v_sub_f32 v120, v84, v96
v_sub_f32 v121, v85, v96
v_sub_f32 v122, v86, v96
v_sub_f32 v123, v87, v96
v_sub_f32 v124, v88, v96
v_sub_f32 v125, v89, v96
v_sub_f32 v126, v90, v96
v_sub_f32 v127, v91, v96
v_sub_f32 v128, v92, v96
v_sub_f32 v129, v93, v96
v_sub_f32 v130, v94, v96
v_sub_f32 v131, v95, v96
v_mul_f32 v98, v100, v100
v_mul_f32 v97, v101, v101
v_fmac_f32 v98, v102, v102
v_fmac_f32 v97, v103, v103
v_fmac_f32 v98, v104, v104
v_fmac_f32 v97, v105, v105
v_fmac_f32 v98, v106, v106
v_fmac_f32 v97, v107, v107
v_fmac_f32 v98, v108, v108
v_fmac_f32 v97, v109, v109
v_fmac_f32 v98, v110, v110
v_fmac_f32 v97, v111, v111
v_fmac_f32 v98, v112, v112
v_fmac_f32 v97, v113, v113
v_fmac_f32 v98, v114, v114
v_fmac_f32 v97, v115, v115
v_fmac_f32 v98, v116, v116
v_fmac_f32 v97, v117, v117
v_fmac_f32 v98, v118, v118
v_fmac_f32 v97, v119, v119
v_fmac_f32 v98, v120, v120
v_fmac_f32 v97, v121, v121
v_fmac_f32 v98, v122, v122
v_fmac_f32 v97, v123, v123
s_mov_b32 exec_lo, -1
s_mov_b32 exec_hi, 0
v_fmac_f32 v98, v124, v124
v_fmac_f32 v97, v125, v125
v_fmac_f32 v98, v126, v126
v_fmac_f32 v97, v127, v127
v_fmac_f32 v98, v128, v128
v_fmac_f32 v97, v129, v129
v_fmac_f32 v98, v130, v130
v_fmac_f32 v97, v131, v131
s_mov_b64 exec, -1
v_add_f32 v98, v98, v97
s_nop 1
v_add_f32_dpp v98, v98, v98 row_ror:4 row_mask:0xf bank_mask:0xf
s_nop 1
v_add_f32_dpp v98, v98, v98 row_ror:8 row_mask:0xf bank_mask:0xf
v_mov_b32 v97, v98
s_nop 1
v_permlane16_swap_b32 v98, v97
v_add_f32 v98, v98, v97
v_mov_b32 v97, v98
s_nop 1
v_permlane32_swap_b32 v98, v97
v_add_f32 v98, v98, v97
v_mul_f32 v98, 0x3b124925, v98
v_cvt_pk_bf16_f32 v96, 0, v96
v_cvt_pk_bf16_f32 v98, 0, v98
v_add_f32 v98, 0x3727c5ac, v98
v_cvt_pk_bf16_f32 v98, 0, v98
v_sqrt_f32 v98, v98
s_nop 0
v_cvt_pk_bf16_f32 v98, 0, v98
v_rcp_f32 v98, v98
v_sub_f32 v64, v64, v96
v_sub_f32 v65, v65, v96
v_sub_f32 v66, v66, v96
v_sub_f32 v67, v67, v96
v_sub_f32 v68, v68, v96
v_sub_f32 v69, v69, v96
v_sub_f32 v70, v70, v96
v_sub_f32 v71, v71, v96
v_sub_f32 v72, v72, v96
v_sub_f32 v73, v73, v96
v_sub_f32 v74, v74, v96
v_sub_f32 v75, v75, v96
v_sub_f32 v76, v76, v96
v_sub_f32 v77, v77, v96
v_sub_f32 v78, v78, v96
v_sub_f32 v79, v79, v96
v_sub_f32 v80, v80, v96
v_sub_f32 v81, v81, v96
v_sub_f32 v82, v82, v96
v_sub_f32 v83, v83, v96
v_sub_f32 v84, v84, v96
v_sub_f32 v85, v85, v96
v_sub_f32 v86, v86, v96
v_sub_f32 v87, v87, v96
v_sub_f32 v88, v88, v96
v_sub_f32 v89, v89, v96
v_sub_f32 v90, v90, v96
v_sub_f32 v91, v91, v96
v_sub_f32 v92, v92, v96
v_sub_f32 v93, v93, v96
v_sub_f32 v94, v94, v96
v_sub_f32 v95, v95, v96
v_cvt_pk_bf16_f32 v48, v64, v65
v_cvt_pk_bf16_f32 v49, v66, v67
v_cvt_pk_bf16_f32 v50, v68, v69
v_cvt_pk_bf16_f32 v51, v70, v71
v_cvt_pk_bf16_f32 v52, v72, v73
v_cvt_pk_bf16_f32 v53, v74, v75
v_cvt_pk_bf16_f32 v54, v76, v77
v_cvt_pk_bf16_f32 v55, v78, v79
v_cvt_pk_bf16_f32 v56, v80, v81
v_cvt_pk_bf16_f32 v57, v82, v83
v_cvt_pk_bf16_f32 v58, v84, v85
v_cvt_pk_bf16_f32 v59, v86, v87
v_cvt_pk_bf16_f32 v60, v88, v89
v_cvt_pk_bf16_f32 v61, v90, v91
v_cvt_pk_bf16_f32 v62, v92, v93
v_cvt_pk_bf16_f32 v63, v94, v95
v_lshlrev_b32 v64, 16, v48
v_and_b32 v65, 0xffff0000, v48
v_lshlrev_b32 v66, 16, v49
v_and_b32 v67, 0xffff0000, v49
v_lshlrev_b32 v68, 16, v50
v_and_b32 v69, 0xffff0000, v50
v_lshlrev_b32 v70, 16, v51
v_and_b32 v71, 0xffff0000, v51
v_lshlrev_b32 v72, 16, v52
v_and_b32 v73, 0xffff0000, v52
v_lshlrev_b32 v74, 16, v53
v_and_b32 v75, 0xffff0000, v53
v_lshlrev_b32 v76, 16, v54
v_and_b32 v77, 0xffff0000, v54
v_lshlrev_b32 v78, 16, v55
v_and_b32 v79, 0xffff0000, v55
v_lshlrev_b32 v80, 16, v56
v_and_b32 v81, 0xffff0000, v56
v_lshlrev_b32 v82, 16, v57
v_and_b32 v83, 0xffff0000, v57
v_lshlrev_b32 v84, 16, v58
v_and_b32 v85, 0xffff0000, v58
v_lshlrev_b32 v86, 16, v59
v_and_b32 v87, 0xffff0000, v59
v_lshlrev_b32 v88, 16, v60
v_and_b32 v89, 0xffff0000, v60
v_lshlrev_b32 v90, 16, v61
v_and_b32 v91, 0xffff0000, v61
v_lshlrev_b32 v92, 16, v62
v_and_b32 v93, 0xffff0000, v62
v_lshlrev_b32 v94, 16, v63
v_and_b32 v95, 0xffff0000, v63
v_mul_f32 v64, v64, v98
v_mul_f32 v65, v65, v98
v_mul_f32 v66, v66, v98
v_mul_f32 v67, v67, v98
v_mul_f32 v68, v68, v98
v_mul_f32 v69, v69, v98
v_mul_f32 v70, v70, v98
v_mul_f32 v71, v71, v98
v_mul_f32 v72, v72, v98
v_mul_f32 v73, v73, v98
v_mul_f32 v74, v74, v98
v_mul_f32 v75, v75, v98
v_mul_f32 v76, v76, v98
v_mul_f32 v77, v77, v98
v_mul_f32 v78, v78, v98
v_mul_f32 v79, v79, v98
v_mul_f32 v80, v80, v98
v_mul_f32 v81, v81, v98
v_mul_f32 v82, v82, v98
v_mul_f32 v83, v83, v98
v_mul_f32 v84, v84, v98
v_mul_f32 v85, v85, v98
v_mul_f32 v86, v86, v98
v_mul_f32 v87, v87, v98
v_mul_f32 v88, v88, v98
v_mul_f32 v89, v89, v98
v_mul_f32 v90, v90, v98
v_mul_f32 v91, v91, v98
v_mul_f32 v92, v92, v98
v_mul_f32 v93, v93, v98
v_mul_f32 v94, v94, v98
v_mul_f32 v95, v95, v98
v_cvt_pk_bf16_f32 v48, v64, v65
v_cvt_pk_bf16_f32 v49, v66, v67
v_cvt_pk_bf16_f32 v50, v68, v69
v_cvt_pk_bf16_f32 v51, v70, v71
v_cvt_pk_bf16_f32 v52, v72, v73
v_cvt_pk_bf16_f32 v53, v74, v75
v_cvt_pk_bf16_f32 v54, v76, v77
v_cvt_pk_bf16_f32 v55, v78, v79
v_cvt_pk_bf16_f32 v56, v80, v81
v_cvt_pk_bf16_f32 v57, v82, v83
v_cvt_pk_bf16_f32 v58, v84, v85
v_cvt_pk_bf16_f32 v59, v86, v87
v_cvt_pk_bf16_f32 v60, v88, v89
v_cvt_pk_bf16_f32 v61, v90, v91
v_cvt_pk_bf16_f32 v62, v92, v93
v_cvt_pk_bf16_f32 v63, v94, v95
v_lshlrev_b32 v64, 16, v48
v_and_b32 v65, 0xffff0000, v48
v_lshlrev_b32 v66, 16, v49
v_and_b32 v67, 0xffff0000, v49
v_lshlrev_b32 v68, 16, v50
v_and_b32 v69, 0xffff0000, v50
v_lshlrev_b32 v70, 16, v51
v_and_b32 v71, 0xffff0000, v51
v_lshlrev_b32 v72, 16, v52
v_and_b32 v73, 0xffff0000, v52
v_lshlrev_b32 v74, 16, v53
v_and_b32 v75, 0xffff0000, v53
v_lshlrev_b32 v76, 16, v54
v_and_b32 v77, 0xffff0000, v54
v_lshlrev_b32 v78, 16, v55
v_and_b32 v79, 0xffff0000, v55
v_lshlrev_b32 v80, 16, v56
v_and_b32 v81, 0xffff0000, v56
v_lshlrev_b32 v82, 16, v57
v_and_b32 v83, 0xffff0000, v57
v_lshlrev_b32 v84, 16, v58
v_and_b32 v85, 0xffff0000, v58
v_lshlrev_b32 v86, 16, v59
v_and_b32 v87, 0xffff0000, v59
v_lshlrev_b32 v88, 16, v60
v_and_b32 v89, 0xffff0000, v60
v_lshlrev_b32 v90, 16, v61
v_and_b32 v91, 0xffff0000, v61
v_lshlrev_b32 v92, 16, v62
v_and_b32 v93, 0xffff0000, v62
v_lshlrev_b32 v94, 16, v63
v_and_b32 v95, 0xffff0000, v63
v_mov_b32 v44, 0
v_mov_b32 v60, 0
v_mov_b32 v45, 0
v_mov_b32 v61, 0
v_mov_b32 v46, 0
v_mov_b32 v62, 0
v_mov_b32 v47, 0
v_mov_b32 v63, 0
v_add_u32 v28, 3584, v2
L_flq:
global_load_dword v99, v17, s[38:39] offset:128 sc1
L_flq_w:
s_waitcnt vmcnt(0)
v_readfirstlane_b32 s12, v99
s_cmp_lg_u32 s12, 0
s_cbranch_scc1 L_flq_done
s_sub_u32 s66, s66, 1
s_cbranch_scc0 L_flq
s_mov_b32 s66, 0
L_flq_done:
s_mov_b32 exec_lo, 1
s_mov_b32 exec_hi, 0
global_store_dwordx4 v27, v[252:255], s[40:41] sc1
s_mov_b64 exec, -1
L_swq:
s_sub_u32 s66, s66, 1
s_cbranch_scc1 L_swq_out
ds_read_b32 v98, v21
s_waitcnt lgkmcnt(0)
v_cmp_eq_u32 vcc, -1, v98
s_cbranch_vccnz L_swq
s_branch L_swq_done
L_swq_out:
s_mov_b32 s66, 0
L_swq_done:
s_mov_b32 s15, 0
L_pma:
global_load_dwordx4 v[32:35], v28, s[40:41] offset:-3584 sc1
global_load_dwordx4 v[48:51], v28, s[40:41] offset:0 sc1
global_load_dwordx4 v[36:39], v28, s[40:41] offset:-2560 sc1
global_load_dwordx4 v[52:55], v28, s[40:41] offset:1024 sc1
global_load_dwordx4 v[40:43], v28, s[40:41] offset:-1536 sc1
global_load_dwordx4 v[56:59], v28, s[40:41] offset:2048 sc1
s_mov_b32 exec_lo, -1
s_mov_b32 exec_hi, 0
global_load_dwordx4 v[44:47], v28, s[40:41] offset:-512 sc1
global_load_dwordx4 v[60:63], v28, s[40:41] offset:3072 sc1
s_mov_b64 exec, -1
s_cmp_lg_u32 s15, 0
s_cbranch_scc1 L_pma_w
ds_read_b64_tr_b16 v[156:157], v22 offset:0
ds_read_b64_tr_b16 v[158:159], v22 offset:4096
ds_read_b64_tr_b16 v[160:161], v23 offset:0
ds_read_b64_tr_b16 v[162:163], v23 offset:4096
ds_read_b64_tr_b16 v[164:165], v24 offset:0
ds_read_b64_tr_b16 v[166:167], v24 offset:4096
ds_read_b64_tr_b16 v[168:169], v25 offset:0
ds_read_b64_tr_b16 v[170:171], v25 offset:4096
ds_read_b64_tr_b16 v[172:173], v22 offset:512
ds_read_b64_tr_b16 v[174:175], v22 offset:4608
ds_read_b64_tr_b16 v[176:177], v23 offset:512
ds_read_b64_tr_b16 v[178:179], v23 offset:4608
ds_read_b64_tr_b16 v[180:181], v24 offset:512
ds_read_b64_tr_b16 v[182:183], v24 offset:4608
ds_read_b64_tr_b16 v[184:185], v25 offset:512
ds_read_b64_tr_b16 v[186:187], v25 offset:4608
ds_read_b64_tr_b16 v[188:189], v22 offset:8192
ds_read_b64_tr_b16 v[190:191], v22 offset:12288
ds_read_b64_tr_b16 v[192:193], v23 offset:8192
ds_read_b64_tr_b16 v[194:195], v23 offset:12288
ds_read_b64_tr_b16 v[196:197], v24 offset:8192
ds_read_b64_tr_b16 v[198:199], v24 offset:12288
ds_read_b64_tr_b16 v[200:201], v25 offset:8192
ds_read_b64_tr_b16 v[202:203], v25 offset:12288
ds_read_b64_tr_b16 v[204:205], v22 offset:8704
ds_read_b64_tr_b16 v[206:207], v22 offset:12800
ds_read_b64_tr_b16 v[208:209], v23 offset:8704
ds_read_b64_tr_b16 v[210:211], v23 offset:12800
ds_read_b64_tr_b16 v[212:213], v24 offset:8704
ds_read_b64_tr_b16 v[214:215], v24 offset:12800
ds_read_b64_tr_b16 v[216:217], v25 offset:8704
ds_read_b64_tr_b16 v[218:219], v25 offset:12800
ds_read_b64_tr_b16 v[220:221], v22 offset:16384
ds_read_b64_tr_b16 v[222:223], v22 offset:20480
ds_read_b64_tr_b16 v[224:225], v23 offset:16384
ds_read_b64_tr_b16 v[226:227], v23 offset:20480
ds_read_b64_tr_b16 v[228:229], v24 offset:16384
ds_read_b64_tr_b16 v[230:231], v24 offset:20480
ds_read_b64_tr_b16 v[232:233], v25 offset:16384
ds_read_b64_tr_b16 v[234:235], v25 offset:20480
ds_read_b64_tr_b16 v[236:237], v22 offset:16896
ds_read_b64_tr_b16 v[238:239], v22 offset:20992
ds_read_b64_tr_b16 v[240:241], v23 offset:16896
ds_read_b64_tr_b16 v[242:243], v23 offset:20992
ds_read_b64_tr_b16 v[244:245], v24 offset:16896
ds_read_b64_tr_b16 v[246:247], v24 offset:20992
ds_read_b64_tr_b16 v[248:249], v25 offset:16896
ds_read_b64_tr_b16 v[250:251], v25 offset:20992
s_mov_b32 s15, 1
L_pma_w:
s_waitcnt vmcnt(0)
v_max3_u32 v96, v32, v33, v34
v_max3_u32 v96, v96, v35, v36
v_max3_u32 v96, v96, v37, v38
v_max3_u32 v96, v96, v39, v40
v_max3_u32 v96, v96, v41, v42
v_max3_u32 v96, v96, v43, v44
v_max3_u32 v96, v96, v45, v46
v_max3_u32 v96, v96, v47, v48
v_max3_u32 v96, v96, v49, v50
v_max3_u32 v96, v96, v51, v52
v_max3_u32 v96, v96, v53, v54
v_max3_u32 v96, v96, v55, v56
v_max3_u32 v96, v96, v57, v58
v_max3_u32 v96, v96, v59, v60
v_max3_u32 v96, v96, v61, v62
v_max_u32 v96, v96, v63
v_cmp_eq_u32 vcc, -1, v96
s_cbranch_vccz L_pma_done
s_sub_u32 s66, s66, 1
s_cbranch_scc0 L_pma
s_mov_b32 s66, 0
L_pma_done:
global_load_dword v98, v29, s[40:41] sc1
global_load_dword v99, v17, s[38:39] offset:132 sc1
v_add_u32 v31, 151552, v10
v_lshlrev_b32 v100, 16, v48
v_and_b32 v101, 0xffff0000, v48
v_lshlrev_b32 v102, 16, v49
v_and_b32 v103, 0xffff0000, v49
v_lshlrev_b32 v104, 16, v50
v_and_b32 v105, 0xffff0000, v50
v_lshlrev_b32 v106, 16, v51
v_and_b32 v107, 0xffff0000, v51
v_mul_f32 v100, v64, v100
v_mul_f32 v101, v65, v101
v_mul_f32 v102, v66, v102
v_mul_f32 v103, v67, v103
v_mul_f32 v104, v68, v104
v_mul_f32 v105, v69, v105
v_mul_f32 v106, v70, v106
v_mul_f32 v107, v71, v107
v_lshlrev_b32 v108, 16, v32
v_and_b32 v109, 0xffff0000, v32
v_lshlrev_b32 v110, 16, v33
v_and_b32 v111, 0xffff0000, v33
v_lshlrev_b32 v112, 16, v34
v_and_b32 v113, 0xffff0000, v34
v_lshlrev_b32 v114, 16, v35
v_and_b32 v115, 0xffff0000, v35
v_cvt_pk_bf16_f32 v116, v100, v101
v_cvt_pk_bf16_f32 v117, v102, v103
v_cvt_pk_bf16_f32 v118, v104, v105
v_cvt_pk_bf16_f32 v119, v106, v107
v_lshlrev_b32 v100, 16, v116
v_and_b32 v101, 0xffff0000, v116
v_lshlrev_b32 v102, 16, v117
v_and_b32 v103, 0xffff0000, v117
v_lshlrev_b32 v104, 16, v118
v_and_b32 v105, 0xffff0000, v118
v_lshlrev_b32 v106, 16, v119
v_and_b32 v107, 0xffff0000, v119
v_add_f32 v100, v100, v108
v_add_f32 v101, v101, v109
v_add_f32 v102, v102, v110
v_add_f32 v103, v103, v111
v_add_f32 v104, v104, v112
v_add_f32 v105, v105, v113
v_add_f32 v106, v106, v114
v_add_f32 v107, v107, v115
v_cvt_pk_bf16_f32 v32, v100, v101
v_cvt_pk_bf16_f32 v33, v102, v103
v_cvt_pk_bf16_f32 v34, v104, v105
v_cvt_pk_bf16_f32 v35, v106, v107
ds_write_b128 v31, v[32:35] offset:0
v_lshlrev_b32 v100, 16, v52
v_and_b32 v101, 0xffff0000, v52
v_lshlrev_b32 v102, 16, v53
v_and_b32 v103, 0xffff0000, v53
v_lshlrev_b32 v104, 16, v54
v_and_b32 v105, 0xffff0000, v54
v_lshlrev_b32 v106, 16, v55
v_and_b32 v107, 0xffff0000, v55
v_mul_f32 v100, v72, v100
v_mul_f32 v101, v73, v101
v_mul_f32 v102, v74, v102
v_mul_f32 v103, v75, v103
v_mul_f32 v104, v76, v104
v_mul_f32 v105, v77, v105
v_mul_f32 v106, v78, v106
v_mul_f32 v107, v79, v107
v_lshlrev_b32 v108, 16, v36
v_and_b32 v109, 0xffff0000, v36
v_lshlrev_b32 v110, 16, v37
v_and_b32 v111, 0xffff0000, v37
v_lshlrev_b32 v112, 16, v38
v_and_b32 v113, 0xffff0000, v38
v_lshlrev_b32 v114, 16, v39
v_and_b32 v115, 0xffff0000, v39
v_cvt_pk_bf16_f32 v116, v100, v101
v_cvt_pk_bf16_f32 v117, v102, v103
v_cvt_pk_bf16_f32 v118, v104, v105
v_cvt_pk_bf16_f32 v119, v106, v107
v_lshlrev_b32 v100, 16, v116
v_and_b32 v101, 0xffff0000, v116
v_lshlrev_b32 v102, 16, v117
v_and_b32 v103, 0xffff0000, v117
v_lshlrev_b32 v104, 16, v118
v_and_b32 v105, 0xffff0000, v118
v_lshlrev_b32 v106, 16, v119
v_and_b32 v107, 0xffff0000, v119
v_add_f32 v100, v100, v108
v_add_f32 v101, v101, v109
v_add_f32 v102, v102, v110
v_add_f32 v103, v103, v111
v_add_f32 v104, v104, v112
v_add_f32 v105, v105, v113
v_add_f32 v106, v106, v114
v_add_f32 v107, v107, v115
v_cvt_pk_bf16_f32 v36, v100, v101
v_cvt_pk_bf16_f32 v37, v102, v103
v_cvt_pk_bf16_f32 v38, v104, v105
v_cvt_pk_bf16_f32 v39, v106, v107
ds_write_b128 v31, v[36:39] offset:256
v_lshlrev_b32 v100, 16, v56
v_and_b32 v101, 0xffff0000, v56
v_lshlrev_b32 v102, 16, v57
v_and_b32 v103, 0xffff0000, v57
v_lshlrev_b32 v104, 16, v58
v_and_b32 v105, 0xffff0000, v58
v_lshlrev_b32 v106, 16, v59
v_and_b32 v107, 0xffff0000, v59
v_mul_f32 v100, v80, v100
v_mul_f32 v101, v81, v101
v_mul_f32 v102, v82, v102
v_mul_f32 v103, v83, v103
v_mul_f32 v104, v84, v104
v_mul_f32 v105, v85, v105
v_mul_f32 v106, v86, v106
v_mul_f32 v107, v87, v107
v_lshlrev_b32 v108, 16, v40
v_and_b32 v109, 0xffff0000, v40
v_lshlrev_b32 v110, 16, v41
v_and_b32 v111, 0xffff0000, v41
v_lshlrev_b32 v112, 16, v42
v_and_b32 v113, 0xffff0000, v42
v_lshlrev_b32 v114, 16, v43
v_and_b32 v115, 0xffff0000, v43
v_cvt_pk_bf16_f32 v116, v100, v101
v_cvt_pk_bf16_f32 v117, v102, v103
v_cvt_pk_bf16_f32 v118, v104, v105
v_cvt_pk_bf16_f32 v119, v106, v107
v_lshlrev_b32 v100, 16, v116
v_and_b32 v101, 0xffff0000, v116
v_lshlrev_b32 v102, 16, v117
v_and_b32 v103, 0xffff0000, v117
v_lshlrev_b32 v104, 16, v118
v_and_b32 v105, 0xffff0000, v118
v_lshlrev_b32 v106, 16, v119
v_and_b32 v107, 0xffff0000, v119
v_add_f32 v100, v100, v108
v_add_f32 v101, v101, v109
v_add_f32 v102, v102, v110
v_add_f32 v103, v103, v111
v_add_f32 v104, v104, v112
v_add_f32 v105, v105, v113
v_add_f32 v106, v106, v114
v_add_f32 v107, v107, v115
v_cvt_pk_bf16_f32 v40, v100, v101
v_cvt_pk_bf16_f32 v41, v102, v103
v_cvt_pk_bf16_f32 v42, v104, v105
v_cvt_pk_bf16_f32 v43, v106, v107
ds_write_b128 v31, v[40:43] offset:512
v_lshlrev_b32 v100, 16, v60
v_and_b32 v101, 0xffff0000, v60
v_lshlrev_b32 v102, 16, v61
v_and_b32 v103, 0xffff0000, v61
v_lshlrev_b32 v104, 16, v62
v_and_b32 v105, 0xffff0000, v62
v_lshlrev_b32 v106, 16, v63
v_and_b32 v107, 0xffff0000, v63
v_mul_f32 v100, v88, v100
v_mul_f32 v101, v89, v101
v_mul_f32 v102, v90, v102
v_mul_f32 v103, v91, v103
v_mul_f32 v104, v92, v104
v_mul_f32 v105, v93, v105
v_mul_f32 v106, v94, v106
v_mul_f32 v107, v95, v107
v_lshlrev_b32 v108, 16, v44
v_and_b32 v109, 0xffff0000, v44
v_lshlrev_b32 v110, 16, v45
v_and_b32 v111, 0xffff0000, v45
v_lshlrev_b32 v112, 16, v46
v_and_b32 v113, 0xffff0000, v46
v_lshlrev_b32 v114, 16, v47
v_and_b32 v115, 0xffff0000, v47
v_cvt_pk_bf16_f32 v116, v100, v101
v_cvt_pk_bf16_f32 v117, v102, v103
v_cvt_pk_bf16_f32 v118, v104, v105
v_cvt_pk_bf16_f32 v119, v106, v107
v_lshlrev_b32 v100, 16, v116
v_and_b32 v101, 0xffff0000, v116
v_lshlrev_b32 v102, 16, v117
v_and_b32 v103, 0xffff0000, v117
v_lshlrev_b32 v104, 16, v118
v_and_b32 v105, 0xffff0000, v118
v_lshlrev_b32 v106, 16, v119
v_and_b32 v107, 0xffff0000, v119
v_add_f32 v100, v100, v108
v_add_f32 v101, v101, v109
v_add_f32 v102, v102, v110
v_add_f32 v103, v103, v111
v_add_f32 v104, v104, v112
v_add_f32 v105, v105, v113
v_add_f32 v106, v106, v114
v_add_f32 v107, v107, v115
v_cvt_pk_bf16_f32 v44, v100, v101
v_cvt_pk_bf16_f32 v45, v102, v103
v_cvt_pk_bf16_f32 v46, v104, v105
v_cvt_pk_bf16_f32 v47, v106, v107
s_mov_b32 exec_lo, -1
s_mov_b32 exec_hi, 0
ds_write_b128 v31, v[44:47] offset:768
s_mov_b64 exec, -1
v_mul_u32_u24 v31, 896, v8
v_lshl_add_u32 v31, v11, 4, v31
v_add_u32 v31, 151552, v31
s_waitcnt lgkmcnt(0)
ds_read2_b64 v[100:103], v31 offset0:0 offset1:8
ds_read2_b64 v[104:107], v31 offset0:1 offset1:9
ds_read2_b64 v[108:111], v31 offset0:16 offset1:24
ds_read2_b64 v[112:115], v31 offset0:17 offset1:25
ds_read2_b64 v[116:119], v31 offset0:32 offset1:40
ds_read2_b64 v[120:123], v31 offset0:33 offset1:41
ds_read2_b64 v[124:127], v31 offset0:48 offset1:56
ds_read2_b64 v[128:131], v31 offset0:49 offset1:57
ds_read2_b64 v[132:135], v31 offset0:64 offset1:72
ds_read2_b64 v[136:139], v31 offset0:65 offset1:73
ds_read2_b64 v[140:143], v31 offset0:80 offset1:88
ds_read2_b64 v[144:147], v31 offset0:81 offset1:89
ds_read2_b64 v[148:151], v31 offset0:96 offset1:104
ds_read2_b64 v[152:155], v31 offset0:97 offset1:105
L_q_pre:
v_and_b32 v16, 4, v0
v_cmp_ne_u32 vcc, 0, v16
s_waitcnt lgkmcnt(0)
v_mfma_f32_16x16x32_bf16 v[32:35], v[156:159], v[100:103], 0
v_mfma_f32_16x16x32_bf16 v[36:39], v[160:163], v[100:103], 0
v_mfma_f32_16x16x32_bf16 v[40:43], v[164:167], v[100:103], 0
v_mfma_f32_16x16x32_bf16 v[44:47], v[168:171], v[100:103], 0
v_mfma_f32_16x16x32_bf16 v[32:35], v[172:175], v[104:107], v[32:35]
v_mfma_f32_16x16x32_bf16 v[36:39], v[176:179], v[104:107], v[36:39]
v_mfma_f32_16x16x32_bf16 v[40:43], v[180:183], v[104:107], v[40:43]
v_mfma_f32_16x16x32_bf16 v[44:47], v[184:187], v[104:107], v[44:47]
ds_read_b64_tr_b16 v[156:157], v22 offset:24576
ds_read_b64_tr_b16 v[158:159], v22 offset:28672
ds_read_b64_tr_b16 v[160:161], v23 offset:24576
ds_read_b64_tr_b16 v[162:163], v23 offset:28672
ds_read_b64_tr_b16 v[164:165], v24 offset:24576
ds_read_b64_tr_b16 v[166:167], v24 offset:28672
ds_read_b64_tr_b16 v[168:169], v25 offset:24576
ds_read_b64_tr_b16 v[170:171], v25 offset:28672
ds_read_b64_tr_b16 v[172:173], v22 offset:25088
ds_read_b64_tr_b16 v[174:175], v22 offset:29184
ds_read_b64_tr_b16 v[176:177], v23 offset:25088
ds_read_b64_tr_b16 v[178:179], v23 offset:29184
ds_read_b64_tr_b16 v[180:181], v24 offset:25088
ds_read_b64_tr_b16 v[182:183], v24 offset:29184
ds_read_b64_tr_b16 v[184:185], v25 offset:25088
ds_read_b64_tr_b16 v[186:187], v25 offset:29184
v_mfma_f32_16x16x32_bf16 v[32:35], v[188:191], v[108:111], v[32:35]
v_mfma_f32_16x16x32_bf16 v[36:39], v[192:195], v[108:111], v[36:39]
v_mfma_f32_16x16x32_bf16 v[40:43], v[196:199], v[108:111], v[40:43]
v_mfma_f32_16x16x32_bf16 v[44:47], v[200:203], v[108:111], v[44:47]
v_mfma_f32_16x16x32_bf16 v[32:35], v[204:207], v[112:115], v[32:35]
v_mfma_f32_16x16x32_bf16 v[36:39], v[208:211], v[112:115], v[36:39]
v_mfma_f32_16x16x32_bf16 v[40:43], v[212:215], v[112:115], v[40:43]
v_mfma_f32_16x16x32_bf16 v[44:47], v[216:219], v[112:115], v[44:47]
ds_read_b64_tr_b16 v[188:189], v22 offset:32768
ds_read_b64_tr_b16 v[190:191], v22 offset:36864
ds_read_b64_tr_b16 v[192:193], v23 offset:32768
ds_read_b64_tr_b16 v[194:195], v23 offset:36864
ds_read_b64_tr_b16 v[196:197], v24 offset:32768
ds_read_b64_tr_b16 v[198:199], v24 offset:36864
ds_read_b64_tr_b16 v[200:201], v25 offset:32768
ds_read_b64_tr_b16 v[202:203], v25 offset:36864
ds_read_b64_tr_b16 v[204:205], v22 offset:33280
ds_read_b64_tr_b16 v[206:207], v22 offset:37376
ds_read_b64_tr_b16 v[208:209], v23 offset:33280
ds_read_b64_tr_b16 v[210:211], v23 offset:37376
ds_read_b64_tr_b16 v[212:213], v24 offset:33280
ds_read_b64_tr_b16 v[214:215], v24 offset:37376
ds_read_b64_tr_b16 v[216:217], v25 offset:33280
ds_read_b64_tr_b16 v[218:219], v25 offset:37376
v_mfma_f32_16x16x32_bf16 v[32:35], v[220:223], v[116:119], v[32:35]
v_mfma_f32_16x16x32_bf16 v[36:39], v[224:227], v[116:119], v[36:39]
v_mfma_f32_16x16x32_bf16 v[40:43], v[228:231], v[116:119], v[40:43]
v_mfma_f32_16x16x32_bf16 v[44:47], v[232:235], v[116:119], v[44:47]
v_mfma_f32_16x16x32_bf16 v[32:35], v[236:239], v[120:123], v[32:35]
v_mfma_f32_16x16x32_bf16 v[36:39], v[240:243], v[120:123], v[36:39]
v_mfma_f32_16x16x32_bf16 v[40:43], v[244:247], v[120:123], v[40:43]
v_mfma_f32_16x16x32_bf16 v[44:47], v[248:251], v[120:123], v[44:47]
ds_read_b64_tr_b16 v[220:221], v22 offset:40960
ds_read_b64_tr_b16 v[222:223], v22 offset:45056
ds_read_b64_tr_b16 v[224:225], v23 offset:40960
ds_read_b64_tr_b16 v[226:227], v23 offset:45056
ds_read_b64_tr_b16 v[228:229], v24 offset:40960
ds_read_b64_tr_b16 v[230:231], v24 offset:45056
ds_read_b64_tr_b16 v[232:233], v25 offset:40960
ds_read_b64_tr_b16 v[234:235], v25 offset:45056
ds_read_b64_tr_b16 v[236:237], v22 offset:41472
ds_read_b64_tr_b16 v[238:239], v22 offset:45568
ds_read_b64_tr_b16 v[240:241], v23 offset:41472
ds_read_b64_tr_b16 v[242:243], v23 offset:45568
ds_read_b64_tr_b16 v[244:245], v24 offset:41472
ds_read_b64_tr_b16 v[246:247], v24 offset:45568
ds_read_b64_tr_b16 v[248:249], v25 offset:41472
ds_read_b64_tr_b16 v[250:251], v25 offset:45568
s_waitcnt lgkmcnt(15)
v_mfma_f32_16x16x32_bf16 v[32:35], v[156:159], v[124:127], v[32:35]
v_mfma_f32_16x16x32_bf16 v[36:39], v[160:163], v[124:127], v[36:39]
v_mfma_f32_16x16x32_bf16 v[40:43], v[164:167], v[124:127], v[40:43]
v_mfma_f32_16x16x32_bf16 v[44:47], v[168:171], v[124:127], v[44:47]
v_mfma_f32_16x16x32_bf16 v[32:35], v[172:175], v[128:131], v[32:35]
v_mfma_f32_16x16x32_bf16 v[36:39], v[176:179], v[128:131], v[36:39]
v_mfma_f32_16x16x32_bf16 v[40:43], v[180:183], v[128:131], v[40:43]
v_mfma_f32_16x16x32_bf16 v[44:47], v[184:187], v[128:131], v[44:47]
ds_read_b64_tr_b16 v[156:157], v22 offset:49152
ds_read_b64_tr_b16 v[158:159], v22 offset:53248
ds_read_b64_tr_b16 v[160:161], v23 offset:49152
ds_read_b64_tr_b16 v[162:163], v23 offset:53248
ds_read_b64_tr_b16 v[164:165], v24 offset:49152
ds_read_b64_tr_b16 v[166:167], v24 offset:53248
ds_read_b64_tr_b16 v[168:169], v25 offset:49152
ds_read_b64_tr_b16 v[170:171], v25 offset:53248
ds_read_b64_tr_b16 v[172:173], v22 offset:49664
ds_read_b64_tr_b16 v[174:175], v22 offset:53760
ds_read_b64_tr_b16 v[176:177], v23 offset:49664
ds_read_b64_tr_b16 v[178:179], v23 offset:53760
ds_read_b64_tr_b16 v[180:181], v24 offset:49664
ds_read_b64_tr_b16 v[182:183], v24 offset:53760
ds_read_b64_tr_b16 v[184:185], v25 offset:49664
ds_read_b64_tr_b16 v[186:187], v25 offset:53760
s_waitcnt lgkmcnt(15)
v_mfma_f32_16x16x32_bf16 v[32:35], v[188:191], v[132:135], v[32:35]
v_mfma_f32_16x16x32_bf16 v[36:39], v[192:195], v[132:135], v[36:39]
v_mfma_f32_16x16x32_bf16 v[40:43], v[196:199], v[132:135], v[40:43]
v_mfma_f32_16x16x32_bf16 v[44:47], v[200:203], v[132:135], v[44:47]
v_mfma_f32_16x16x32_bf16 v[32:35], v[204:207], v[136:139], v[32:35]
v_mfma_f32_16x16x32_bf16 v[36:39], v[208:211], v[136:139], v[36:39]
v_mfma_f32_16x16x32_bf16 v[40:43], v[212:215], v[136:139], v[40:43]
v_mfma_f32_16x16x32_bf16 v[44:47], v[216:219], v[136:139], v[44:47]
ds_read_b64_tr_b16 v[188:189], v12 offset:0
ds_read_b64_tr_b16 v[190:191], v12 offset:4096
ds_read_b64_tr_b16 v[192:193], v13 offset:0
ds_read_b64_tr_b16 v[194:195], v13 offset:4096
ds_read_b64_tr_b16 v[196:197], v14 offset:0
ds_read_b64_tr_b16 v[198:199], v14 offset:4096
ds_read_b64_tr_b16 v[200:201], v15 offset:0
ds_read_b64_tr_b16 v[202:203], v15 offset:4096
ds_read_b64_tr_b16 v[204:205], v12 offset:512
ds_read_b64_tr_b16 v[206:207], v12 offset:4608
ds_read_b64_tr_b16 v[208:209], v13 offset:512
ds_read_b64_tr_b16 v[210:211], v13 offset:4608
ds_read_b64_tr_b16 v[212:213], v14 offset:512
ds_read_b64_tr_b16 v[214:215], v14 offset:4608
ds_read_b64_tr_b16 v[216:217], v15 offset:512
ds_read_b64_tr_b16 v[218:219], v15 offset:4608
s_waitcnt lgkmcnt(15)
v_mfma_f32_16x16x32_bf16 v[32:35], v[220:223], v[140:143], v[32:35]
v_mfma_f32_16x16x32_bf16 v[36:39], v[224:227], v[140:143], v[36:39]
v_mfma_f32_16x16x32_bf16 v[40:43], v[228:231], v[140:143], v[40:43]
v_mfma_f32_16x16x32_bf16 v[44:47], v[232:235], v[140:143], v[44:47]
v_mfma_f32_16x16x32_bf16 v[32:35], v[236:239], v[144:147], v[32:35]
v_mfma_f32_16x16x32_bf16 v[36:39], v[240:243], v[144:147], v[36:39]
v_mfma_f32_16x16x32_bf16 v[40:43], v[244:247], v[144:147], v[40:43]
v_mfma_f32_16x16x32_bf16 v[44:47], v[248:251], v[144:147], v[44:47]
ds_read_b64_tr_b16 v[220:221], v12 offset:8192
ds_read_b64_tr_b16 v[222:223], v12 offset:12288
ds_read_b64_tr_b16 v[224:225], v13 offset:8192
ds_read_b64_tr_b16 v[226:227], v13 offset:12288
ds_read_b64_tr_b16 v[228:229], v14 offset:8192
ds_read_b64_tr_b16 v[230:231], v14 offset:12288
ds_read_b64_tr_b16 v[232:233], v15 offset:8192
ds_read_b64_tr_b16 v[234:235], v15 offset:12288
ds_read_b64_tr_b16 v[236:237], v12 offset:8704
ds_read_b64_tr_b16 v[238:239], v12 offset:12800
ds_read_b64_tr_b16 v[240:241], v13 offset:8704
ds_read_b64_tr_b16 v[242:243], v13 offset:12800
ds_read_b64_tr_b16 v[244:245], v14 offset:8704
ds_read_b64_tr_b16 v[246:247], v14 offset:12800
ds_read_b64_tr_b16 v[248:249], v15 offset:8704
ds_read_b64_tr_b16 v[250:251], v15 offset:12800
s_waitcnt lgkmcnt(15)
v_mfma_f32_16x16x32_bf16 v[32:35], v[156:159], v[148:151], v[32:35]
v_mfma_f32_16x16x32_bf16 v[36:39], v[160:163], v[148:151], v[36:39]
v_mfma_f32_16x16x32_bf16 v[40:43], v[164:167], v[148:151], v[40:43]
v_mfma_f32_16x16x32_bf16 v[44:47], v[168:171], v[148:151], v[44:47]
v_mfma_f32_16x16x32_bf16 v[32:35], v[172:175], v[152:155], v[32:35]
v_mfma_f32_16x16x32_bf16 v[36:39], v[176:179], v[152:155], v[36:39]
v_mfma_f32_16x16x32_bf16 v[40:43], v[180:183], v[152:155], v[40:43]
v_mfma_f32_16x16x32_bf16 v[44:47], v[184:187], v[152:155], v[44:47]
ds_read_b64_tr_b16 v[156:157], v12 offset:16384
ds_read_b64_tr_b16 v[158:159], v12 offset:20480
ds_read_b64_tr_b16 v[160:161], v13 offset:16384
ds_read_b64_tr_b16 v[162:163], v13 offset:20480
ds_read_b64_tr_b16 v[164:165], v14 offset:16384
ds_read_b64_tr_b16 v[166:167], v14 offset:20480
ds_read_b64_tr_b16 v[168:169], v15 offset:16384
ds_read_b64_tr_b16 v[170:171], v15 offset:20480
ds_read_b64_tr_b16 v[172:173], v12 offset:16896
ds_read_b64_tr_b16 v[174:175], v12 offset:20992
ds_read_b64_tr_b16 v[176:177], v13 offset:16896
ds_read_b64_tr_b16 v[178:179], v13 offset:20992
ds_read_b64_tr_b16 v[180:181], v14 offset:16896
ds_read_b64_tr_b16 v[182:183], v14 offset:20992
ds_read_b64_tr_b16 v[184:185], v15 offset:16896
ds_read_b64_tr_b16 v[186:187], v15 offset:20992
s_waitcnt lgkmcnt(15)
v_mfma_f32_16x16x32_bf16 v[48:51], v[188:191], v[100:103], 0
v_mfma_f32_16x16x32_bf16 v[52:55], v[192:195], v[100:103], 0
v_mfma_f32_16x16x32_bf16 v[56:59], v[196:199], v[100:103], 0
v_mfma_f32_16x16x32_bf16 v[60:63], v[200:203], v[100:103], 0
v_mfma_f32_16x16x32_bf16 v[48:51], v[204:207], v[104:107], v[48:51]
v_mfma_f32_16x16x32_bf16 v[52:55], v[208:211], v[104:107], v[52:55]
v_mfma_f32_16x16x32_bf16 v[56:59], v[212:215], v[104:107], v[56:59]
v_mfma_f32_16x16x32_bf16 v[60:63], v[216:219], v[104:107], v[60:63]
ds_read_b64_tr_b16 v[188:189], v12 offset:24576
ds_read_b64_tr_b16 v[190:191], v12 offset:28672
ds_read_b64_tr_b16 v[192:193], v13 offset:24576
ds_read_b64_tr_b16 v[194:195], v13 offset:28672
ds_read_b64_tr_b16 v[196:197], v14 offset:24576
ds_read_b64_tr_b16 v[198:199], v14 offset:28672
ds_read_b64_tr_b16 v[200:201], v15 offset:24576
ds_read_b64_tr_b16 v[202:203], v15 offset:28672
ds_read_b64_tr_b16 v[204:205], v12 offset:25088
ds_read_b64_tr_b16 v[206:207], v12 offset:29184
ds_read_b64_tr_b16 v[208:209], v13 offset:25088
ds_read_b64_tr_b16 v[210:211], v13 offset:29184
ds_read_b64_tr_b16 v[212:213], v14 offset:25088
ds_read_b64_tr_b16 v[214:215], v14 offset:29184
ds_read_b64_tr_b16 v[216:217], v15 offset:25088
ds_read_b64_tr_b16 v[218:219], v15 offset:29184
s_waitcnt lgkmcnt(15)
v_mfma_f32_16x16x32_bf16 v[48:51], v[220:223], v[108:111], v[48:51]
v_mfma_f32_16x16x32_bf16 v[52:55], v[224:227], v[108:111], v[52:55]
v_mfma_f32_16x16x32_bf16 v[56:59], v[228:231], v[108:111], v[56:59]
v_mfma_f32_16x16x32_bf16 v[60:63], v[232:235], v[108:111], v[60:63]
v_mfma_f32_16x16x32_bf16 v[48:51], v[236:239], v[112:115], v[48:51]
v_mfma_f32_16x16x32_bf16 v[52:55], v[240:243], v[112:115], v[52:55]
v_mfma_f32_16x16x32_bf16 v[56:59], v[244:247], v[112:115], v[56:59]
v_mfma_f32_16x16x32_bf16 v[60:63], v[248:251], v[112:115], v[60:63]
ds_read_b64_tr_b16 v[220:221], v12 offset:32768
ds_read_b64_tr_b16 v[222:223], v12 offset:36864
ds_read_b64_tr_b16 v[224:225], v13 offset:32768
ds_read_b64_tr_b16 v[226:227], v13 offset:36864
ds_read_b64_tr_b16 v[228:229], v14 offset:32768
ds_read_b64_tr_b16 v[230:231], v14 offset:36864
ds_read_b64_tr_b16 v[232:233], v15 offset:32768
ds_read_b64_tr_b16 v[234:235], v15 offset:36864
ds_read_b64_tr_b16 v[236:237], v12 offset:33280
ds_read_b64_tr_b16 v[238:239], v12 offset:37376
ds_read_b64_tr_b16 v[240:241], v13 offset:33280
ds_read_b64_tr_b16 v[242:243], v13 offset:37376
ds_read_b64_tr_b16 v[244:245], v14 offset:33280
ds_read_b64_tr_b16 v[246:247], v14 offset:37376
ds_read_b64_tr_b16 v[248:249], v15 offset:33280
ds_read_b64_tr_b16 v[250:251], v15 offset:37376
s_waitcnt lgkmcnt(15)
v_mfma_f32_16x16x32_bf16 v[48:51], v[156:159], v[116:119], v[48:51]
v_mfma_f32_16x16x32_bf16 v[52:55], v[160:163], v[116:119], v[52:55]
v_mfma_f32_16x16x32_bf16 v[56:59], v[164:167], v[116:119], v[56:59]
v_mfma_f32_16x16x32_bf16 v[60:63], v[168:171], v[116:119], v[60:63]
v_mfma_f32_16x16x32_bf16 v[48:51], v[172:175], v[120:123], v[48:51]
v_mfma_f32_16x16x32_bf16 v[52:55], v[176:179], v[120:123], v[52:55]
v_mfma_f32_16x16x32_bf16 v[56:59], v[180:183], v[120:123], v[56:59]
v_mfma_f32_16x16x32_bf16 v[60:63], v[184:187], v[120:123], v[60:63]
ds_read_b64_tr_b16 v[156:157], v12 offset:40960
ds_read_b64_tr_b16 v[158:159], v12 offset:45056
ds_read_b64_tr_b16 v[160:161], v13 offset:40960
ds_read_b64_tr_b16 v[162:163], v13 offset:45056
ds_read_b64_tr_b16 v[164:165], v14 offset:40960
ds_read_b64_tr_b16 v[166:167], v14 offset:45056
ds_read_b64_tr_b16 v[168:169], v15 offset:40960
ds_read_b64_tr_b16 v[170:171], v15 offset:45056
ds_read_b64_tr_b16 v[172:173], v12 offset:41472
ds_read_b64_tr_b16 v[174:175], v12 offset:45568
ds_read_b64_tr_b16 v[176:177], v13 offset:41472
ds_read_b64_tr_b16 v[178:179], v13 offset:45568
ds_read_b64_tr_b16 v[180:181], v14 offset:41472
ds_read_b64_tr_b16 v[182:183], v14 offset:45568
ds_read_b64_tr_b16 v[184:185], v15 offset:41472
ds_read_b64_tr_b16 v[186:187], v15 offset:45568
s_waitcnt lgkmcnt(15)
v_mfma_f32_16x16x32_bf16 v[48:51], v[188:191], v[124:127], v[48:51]
v_mfma_f32_16x16x32_bf16 v[52:55], v[192:195], v[124:127], v[52:55]
v_mfma_f32_16x16x32_bf16 v[56:59], v[196:199], v[124:127], v[56:59]
v_mfma_f32_16x16x32_bf16 v[60:63], v[200:203], v[124:127], v[60:63]
v_mfma_f32_16x16x32_bf16 v[48:51], v[204:207], v[128:131], v[48:51]
v_mfma_f32_16x16x32_bf16 v[52:55], v[208:211], v[128:131], v[52:55]
v_mfma_f32_16x16x32_bf16 v[56:59], v[212:215], v[128:131], v[56:59]
v_mfma_f32_16x16x32_bf16 v[60:63], v[216:219], v[128:131], v[60:63]
ds_read_b64_tr_b16 v[188:189], v12 offset:49152
ds_read_b64_tr_b16 v[190:191], v12 offset:53248
ds_read_b64_tr_b16 v[192:193], v13 offset:49152
ds_read_b64_tr_b16 v[194:195], v13 offset:53248
ds_read_b64_tr_b16 v[196:197], v14 offset:49152
ds_read_b64_tr_b16 v[198:199], v14 offset:53248
ds_read_b64_tr_b16 v[200:201], v15 offset:49152
ds_read_b64_tr_b16 v[202:203], v15 offset:53248
ds_read_b64_tr_b16 v[204:205], v12 offset:49664
ds_read_b64_tr_b16 v[206:207], v12 offset:53760
ds_read_b64_tr_b16 v[208:209], v13 offset:49664
ds_read_b64_tr_b16 v[210:211], v13 offset:53760
ds_read_b64_tr_b16 v[212:213], v14 offset:49664
ds_read_b64_tr_b16 v[214:215], v14 offset:53760
ds_read_b64_tr_b16 v[216:217], v15 offset:49664
ds_read_b64_tr_b16 v[218:219], v15 offset:53760
s_waitcnt lgkmcnt(15)
v_mfma_f32_16x16x32_bf16 v[48:51], v[220:223], v[132:135], v[48:51]
v_mfma_f32_16x16x32_bf16 v[52:55], v[224:227], v[132:135], v[52:55]
v_mfma_f32_16x16x32_bf16 v[56:59], v[228:231], v[132:135], v[56:59]
v_mfma_f32_16x16x32_bf16 v[60:63], v[232:235], v[132:135], v[60:63]
v_mfma_f32_16x16x32_bf16 v[48:51], v[236:239], v[136:139], v[48:51]
v_mfma_f32_16x16x32_bf16 v[52:55], v[240:243], v[136:139], v[52:55]
v_mfma_f32_16x16x32_bf16 v[56:59], v[244:247], v[136:139], v[56:59]
v_mfma_f32_16x16x32_bf16 v[60:63], v[248:251], v[136:139], v[60:63]
s_waitcnt lgkmcnt(15)
v_mfma_f32_16x16x32_bf16 v[48:51], v[156:159], v[140:143], v[48:51]
v_mfma_f32_16x16x32_bf16 v[52:55], v[160:163], v[140:143], v[52:55]
v_mfma_f32_16x16x32_bf16 v[56:59], v[164:167], v[140:143], v[56:59]
v_mfma_f32_16x16x32_bf16 v[60:63], v[168:171], v[140:143], v[60:63]
v_mfma_f32_16x16x32_bf16 v[48:51], v[172:175], v[144:147], v[48:51]
v_mfma_f32_16x16x32_bf16 v[52:55], v[176:179], v[144:147], v[52:55]
v_mfma_f32_16x16x32_bf16 v[56:59], v[180:183], v[144:147], v[56:59]
v_mfma_f32_16x16x32_bf16 v[60:63], v[184:187], v[144:147], v[60:63]
s_waitcnt lgkmcnt(0)
v_mfma_f32_16x16x32_bf16 v[48:51], v[188:191], v[148:151], v[48:51]
v_mfma_f32_16x16x32_bf16 v[52:55], v[192:195], v[148:151], v[52:55]
v_mfma_f32_16x16x32_bf16 v[56:59], v[196:199], v[148:151], v[56:59]
v_mfma_f32_16x16x32_bf16 v[60:63], v[200:203], v[148:151], v[60:63]
v_mfma_f32_16x16x32_bf16 v[48:51], v[204:207], v[152:155], v[48:51]
v_mfma_f32_16x16x32_bf16 v[52:55], v[208:211], v[152:155], v[52:55]
v_mfma_f32_16x16x32_bf16 v[56:59], v[212:215], v[152:155], v[56:59]
v_mfma_f32_16x16x32_bf16 v[60:63], v[216:219], v[152:155], v[60:63]
v_cvt_pk_bf16_f32 v64, v32, v33
v_cvt_pk_bf16_f32 v65, v34, v35
v_cvt_pk_bf16_f32 v66, v36, v37
v_cvt_pk_bf16_f32 v67, v38, v39
v_cvt_pk_bf16_f32 v68, v40, v41
v_cvt_pk_bf16_f32 v69, v42, v43
v_cvt_pk_bf16_f32 v70, v44, v45
v_cvt_pk_bf16_f32 v71, v46, v47
v_permlane16_swap_b32 v64, v66
v_permlane16_swap_b32 v65, v67
v_permlane16_swap_b32 v68, v70
v_permlane16_swap_b32 v69, v71
v_cndmask_b32 v72, v64, v68, vcc
v_cndmask_b32 v73, v65, v69, vcc
v_cndmask_b32 v74, v66, v70, vcc
v_cndmask_b32 v75, v67, v71, vcc
v_min_u32 v72, -2, v72
v_min_u32 v73, -2, v73
v_min_u32 v74, -2, v74
v_min_u32 v75, -2, v75
v_cvt_pk_bf16_f32 v64, v48, v49
v_cvt_pk_bf16_f32 v65, v50, v51
v_cvt_pk_bf16_f32 v66, v52, v53
v_cvt_pk_bf16_f32 v67, v54, v55
v_cvt_pk_bf16_f32 v68, v56, v57
v_cvt_pk_bf16_f32 v69, v58, v59
v_cvt_pk_bf16_f32 v70, v60, v61
v_cvt_pk_bf16_f32 v71, v62, v63
v_permlane16_swap_b32 v64, v66
v_permlane16_swap_b32 v65, v67
v_permlane16_swap_b32 v68, v70
v_permlane16_swap_b32 v69, v71
v_cndmask_b32 v76, v64, v68, vcc
v_cndmask_b32 v77, v65, v69, vcc
v_cndmask_b32 v78, v66, v70, vcc
v_cndmask_b32 v79, v67, v71, vcc
v_min_u32 v76, -2, v76
v_min_u32 v77, -2, v77
v_min_u32 v78, -2, v78
v_min_u32 v79, -2, v79
s_branch L_flq2_w
L_flq2:
global_load_dword v99, v17, s[38:39] offset:132 sc1
L_flq2_w:
s_waitcnt vmcnt(0)
v_readfirstlane_b32 s12, v99
s_cmp_lg_u32 s12, 0
s_cbranch_scc1 L_flq2_done
s_sub_u32 s66, s66, 1
s_cbranch_scc0 L_flq2
s_mov_b32 s66, 0
L_flq2_done:
s_branch L_xtq_w
L_xtq:
global_load_dword v98, v29, s[40:41] sc1
L_xtq_w:
s_waitcnt vmcnt(0)
v_cmp_eq_u32 vcc, -1, v98
s_cbranch_vccz L_xtq_done
s_sub_u32 s66, s66, 1
s_cbranch_scc0 L_xtq
s_mov_b32 s66, 0
L_xtq_done:
v_cmp_ne_u32 vcc, s8, v98
s_cmp_eq_u64 vcc, 0
s_cselect_b32 s68, 1, 0
s_mov_b32 exec_lo, 0x00ff00ff
s_mov_b32 exec_hi, 0x00ff00ff
s_cbranch_scc1 L_q_near
global_store_dwordx4 v30, v[72:75], s[40:41] sc1
global_store_dwordx4 v30, v[76:79], s[40:41] offset:128 sc1
s_branch L_q_put
L_q_near:
global_store_dwordx4 v30, v[72:75], s[40:41]
global_store_dwordx4 v30, v[76:79], s[40:41] offset:128
L_q_put:
s_mov_b64 exec, -1
s_branch L_pollq
L_common:
L_flc:
global_load_dword v99, v17, s[38:39] offset:128 sc1
L_flc_w:
s_waitcnt vmcnt(0)
v_readfirstlane_b32 s12, v99
s_cmp_lg_u32 s12, 0
s_cbranch_scc1 L_flc_done
s_sub_u32 s66, s66, 1
s_cbranch_scc0 L_flc
s_mov_b32 s66, 0
L_flc_done:
L_common2:
s_mov_b32 exec_lo, 1
s_mov_b32 exec_hi, 0
global_store_dwordx4 v27, v[252:255], s[40:41] sc1
s_mov_b64 exec, -1
L_fll:
global_load_dword v99, v17, s[38:39] offset:132 sc1
L_fll_w:
s_waitcnt vmcnt(0)
v_readfirstlane_b32 s12, v99
s_cmp_lg_u32 s12, 0
s_cbranch_scc1 L_fll_done
s_sub_u32 s66, s66, 1
s_cbranch_scc0 L_fll
s_mov_b32 s66, 0
L_fll_done:
L_common3:
global_load_dword v98, v29, s[40:41] sc1
s_cmp_lt_u32 s7, 7
s_cselect_b32 s67, 57344, 0
s_cselect_b32 s68, 225856, 0
s_lshl_b32 s12, s4, 9
s_lshl_b32 s13, s3, 6
s_add_u32 s12, s12, s13
s_mul_i32 s12, s12, 896
s_lshl_b32 s13, s7, 7
s_add_u32 s12, s12, s13
s_add_u32 s52, s24, s12
s_addc_u32 s53, s25, 0
s_and_b32 s53, s53, 0xffff
s_mov_b32 s54, s67
s_mov_b32 s55, 0x20000
s_mul_i32 s12, s3, 229376
s_lshl_b32 s13, s10, 6
s_add_u32 s12, s12, s13
s_add_u32 s56, s28, s12
s_addc_u32 s57, s29, 0
s_and_b32 s57, s57, 0xffff
s_mov_b32 s58, s68
s_mov_b32 s59, 0x20000
s_mul_i32 s12, s10, 28672
s_lshl_b32 s13, s3, 7
s_add_u32 s12, s12, s13
s_cmp_lt_u32 s7, 7
s_cselect_b32 s67, 27904, 0
s_add_u32 s60, s30, s12
s_addc_u32 s61, s31, 0
s_and_b32 s61, s61, 0xffff
s_mov_b32 s62, s67
s_mov_b32 s63, 0x20000
s_lshl_b32 s42, s3, 13
s_lshl_b32 s12, s3, 12
s_add_u32 s43, s12, 65536
s_add_u32 s64, s12, 94208
s_cmp_lt_u32 s7, 7
s_cselect_b32 s42, s42, 114688
s_cselect_b32 s43, s43, 114688
s_cselect_b32 s64, s64, 114688
v_lshrrev_b32 v253, 3, v0
v_mul_u32_u24 v248, 896, v253
v_and_b32 v253, 2, v253
v_and_b32 v252, 7, v0
v_xor_b32 v253, v253, v252
v_xor_b32 v252, 4, v253
v_lshl_add_u32 v253, v253, 4, v248
v_lshl_add_u32 v252, v252, 4, v248
v_lshrrev_b32 v254, 2, v0
v_mul_u32_u24 v254, 3584, v254
v_lshrrev_b32 v248, 4, v0
v_and_b32 v248, 2, v248
v_and_b32 v249, 3, v0
v_xor_b32 v248, v248, v249
v_lshl_add_u32 v254, v248, 4, v254
s_add_u32 m0, s42, 0
s_mov_b32 s69, 0
buffer_load_dwordx4 v253, s[52:55], s69 offen nt lds
s_add_u32 m0, s42, 1024
s_mov_b32 s69, 7168
buffer_load_dwordx4 v252, s[52:55], s69 offen nt lds
s_add_u32 m0, s42, 2048
s_mov_b32 s69, 14336
buffer_load_dwordx4 v253, s[52:55], s69 offen nt lds
s_add_u32 m0, s42, 3072
s_mov_b32 s69, 21504
buffer_load_dwordx4 v252, s[52:55], s69 offen nt lds
s_add_u32 m0, s42, 4096
s_mov_b32 s69, 28672
buffer_load_dwordx4 v253, s[52:55], s69 offen nt lds
s_add_u32 m0, s42, 5120
s_mov_b32 s69, 35840
buffer_load_dwordx4 v252, s[52:55], s69 offen nt lds
s_add_u32 m0, s42, 6144
s_mov_b32 s69, 43008
buffer_load_dwordx4 v253, s[52:55], s69 offen nt lds
s_add_u32 m0, s42, 7168
s_mov_b32 s69, 50176
buffer_load_dwordx4 v252, s[52:55], s69 offen nt lds
s_branch L_xtc_w
L_xtc:
global_load_dword v98, v29, s[40:41] sc1
L_xtc_w:
s_waitcnt vmcnt(0)
v_cmp_eq_u32 vcc, -1, v98
s_cbranch_vccz L_xtc_done
s_sub_u32 s66, s66, 1
s_cbranch_scc0 L_xtc
s_mov_b32 s66, 0
L_xtc_done:
v_cmp_ne_u32 vcc, s8, v98
s_cmp_eq_u64 vcc, 0
s_cselect_b32 s68, 1, 0
L_pollq:
v_mov_b32 v30, 156176
v_mov_b32 v31, s68
s_mov_b32 exec_lo, 1
s_mov_b32 exec_hi, 0
ds_write_b32 v30, v31
s_mov_b64 exec, -1
s_lshl_b32 s12, s9, 10
s_add_u32 s12, s12, 65536
v_add_u32 v31, s12, v1
v_add_u32 v30, 155136, v2
s_mov_b32 exec_lo, 0
s_mov_b32 exec_hi, 0xff
L_pq0:
global_load_dwordx4 v[32:35], v31, s[40:41] sc1
s_waitcnt vmcnt(0)
v_max3_u32 v36, v32, v33, v34
v_max_u32 v36, v36, v35
v_cmp_eq_u32 vcc, -1, v36
s_cbranch_vccz L_pq0_done
s_sub_u32 s66, s66, 1
s_cbranch_scc0 L_pq0
s_mov_b32 s66, 0
L_pq0_done:
s_mov_b32 exec_lo, -1
s_mov_b32 exec_hi, 0xffffff00
L_pq:
global_load_dwordx4 v[32:35], v31, s[40:41] sc1
s_waitcnt vmcnt(0)
v_max3_u32 v36, v32, v33, v34
v_max_u32 v36, v36, v35
v_cmp_eq_u32 vcc, -1, v36
s_cbranch_vccz L_pq_done
s_mov_b64 exec, vcc
s_sub_u32 s66, s66, 1
s_cbranch_scc0 L_pq
s_mov_b32 s66, 0
L_pq_done:
s_mov_b64 exec, -1
ds_write_b128 v30, v[32:35]
s_cmp_eq_u32 s7, 7
s_cbranch_scc1 L_stats
s_mul_i32 s12, s6, 3584
s_add_u32 s12, s12, 1114112
v_add_u32 v31, s12, v2
s_mul_i32 s12, s6, 896
v_add_u32 v30, s12, v2
s_mov_b32 exec_lo, -1
s_mov_b32 exec_hi, 0x00ffffff
global_load_dwordx4 v[48:51], v30, s[16:17]
L_pm:
global_load_dwordx4 v[32:35], v31, s[40:41] offset:0 sc1
global_load_dwordx4 v[36:39], v31, s[40:41] offset:896 sc1
global_load_dwordx4 v[40:43], v31, s[40:41] offset:1792 sc1
global_load_dwordx4 v[44:47], v31, s[40:41] offset:2688 sc1
s_waitcnt vmcnt(0)
v_max3_u32 v52, v32, v33, v34
v_max3_u32 v52, v52, v35, v36
v_max3_u32 v52, v52, v37, v38
v_max3_u32 v52, v52, v39, v40
v_max3_u32 v52, v52, v41, v42
v_max3_u32 v52, v52, v43, v44
v_max3_u32 v52, v52, v45, v46
v_max_u32 v52, v52, v47
v_cmp_eq_u32 vcc, -1, v52
s_cbranch_vccz L_pm_done
s_sub_u32 s66, s66, 1
s_cbranch_scc0 L_pm
s_mov_b32 s66, 0
L_pm_done:
v_lshlrev_b32 v30, 5, v0
v_add_u32 v30, 137728, v30
v_lshlrev_b32 v64, 16, v32
v_and_b32 v65, 0xffff0000, v32
v_lshlrev_b32 v66, 16, v33
v_and_b32 v67, 0xffff0000, v33
v_lshlrev_b32 v68, 16, v34
v_and_b32 v69, 0xffff0000, v34
v_lshlrev_b32 v70, 16, v35
v_and_b32 v71, 0xffff0000, v35
ds_write_b128 v30, v[64:67] offset:0
ds_write_b128 v30, v[68:71] offset:16
s_waitcnt lgkmcnt(0)
v_lshlrev_b32 v64, 16, v36
v_and_b32 v65, 0xffff0000, v36
v_lshlrev_b32 v66, 16, v37
v_and_b32 v67, 0xffff0000, v37
v_lshlrev_b32 v68, 16, v38
v_and_b32 v69, 0xffff0000, v38
v_lshlrev_b32 v70, 16, v39
v_and_b32 v71, 0xffff0000, v39
ds_write_b128 v30, v[64:67] offset:5376
ds_write_b128 v30, v[68:71] offset:5392
s_waitcnt lgkmcnt(0)
v_lshlrev_b32 v64, 16, v40
v_and_b32 v65, 0xffff0000, v40
v_lshlrev_b32 v66, 16, v41
v_and_b32 v67, 0xffff0000, v41
v_lshlrev_b32 v68, 16, v42
v_and_b32 v69, 0xffff0000, v42
v_lshlrev_b32 v70, 16, v43
v_and_b32 v71, 0xffff0000, v43
ds_write_b128 v30, v[64:67] offset:3584
ds_write_b128 v30, v[68:71] offset:3600
s_waitcnt lgkmcnt(0)
v_lshlrev_b32 v64, 16, v44
v_and_b32 v65, 0xffff0000, v44
v_lshlrev_b32 v66, 16, v45
v_and_b32 v67, 0xffff0000, v45
v_lshlrev_b32 v68, 16, v46
v_and_b32 v69, 0xffff0000, v46
v_lshlrev_b32 v70, 16, v47
v_and_b32 v71, 0xffff0000, v47
ds_write_b128 v30, v[64:67] offset:7168
ds_write_b128 v30, v[68:71] offset:7184
s_waitcnt lgkmcnt(0)
v_lshlrev_b32 v64, 16, v48
v_and_b32 v65, 0xffff0000, v48
v_lshlrev_b32 v66, 16, v49
v_and_b32 v67, 0xffff0000, v49
v_lshlrev_b32 v68, 16, v50
v_and_b32 v69, 0xffff0000, v50
v_lshlrev_b32 v70, 16, v51
v_and_b32 v71, 0xffff0000, v51
ds_write_b128 v30, v[64:67] offset:1792
ds_write_b128 v30, v[68:71] offset:1808
s_waitcnt lgkmcnt(0)
s_mov_b64 exec, -1
v_lshlrev_b32 v30, 2, v0
v_add_u32 v30, 160240, v30
s_mov_b32 exec_lo, -1
s_mov_b32 exec_hi, 0xf
ds_write_b32 v30, v17
s_mov_b64 exec, -1
L_stats:
s_lshl_b32 s12, s9, 10
s_add_u32 s12, s12, 98304
v_add_u32 v31, s12, v2
v_mov_b32 v32, 0xff800000
v_mov_b32 v33, 0
v_mov_b32 v34, 0xff800000
v_mov_b32 v35, 0
s_mov_b32 exec_lo, 0x7f7f7f7f
s_mov_b32 exec_hi, 0x7f7f7f7f
L_ps:
global_load_dwordx4 v[32:35], v31, s[40:41] sc1
s_waitcnt vmcnt(0)
v_max3_u32 v36, v32, v33, v34
v_max_u32 v36, v36, v35
v_cmp_eq_u32 vcc, -1, v36
s_cbranch_vccz L_ps_done
s_mov_b64 exec, vcc
s_sub_u32 s66, s66, 1
s_cbranch_scc0 L_ps
s_mov_b32 s66, 0
L_ps_done:
s_mov_b64 exec, -1
v_mov_b32 v36, v32
v_mov_b32 v38, v34
s_mov_b32 s12, 0x3db8aa3b
v_max_f32_dpp v36, v36, v36 row_ror:8 row_mask:0xf bank_mask:0xf
v_max_f32_dpp v38, v38, v38 row_ror:8 row_mask:0xf bank_mask:0xf
s_nop 0
v_max_f32_dpp v36, v36, v36 row_ror:4 row_mask:0xf bank_mask:0xf
v_max_f32_dpp v38, v38, v38 row_ror:4 row_mask:0xf bank_mask:0xf
s_nop 0
v_max_f32_dpp v36, v36, v36 row_ror:2 row_mask:0xf bank_mask:0xf
v_max_f32_dpp v38, v38, v38 row_ror:2 row_mask:0xf bank_mask:0xf
s_nop 0
v_max_f32_dpp v36, v36, v36 row_ror:1 row_mask:0xf bank_mask:0xf
v_max_f32_dpp v38, v38, v38 row_ror:1 row_mask:0xf bank_mask:0xf
v_mov_b32 v40, v36
v_mov_b32 v41, v38
s_nop 0
v_permlane16_swap_b32 v36, v40
v_permlane16_swap_b32 v38, v41
v_max_f32 v36, v36, v40
v_max_f32 v38, v38, v41
v_mov_b32 v40, v36
v_mov_b32 v41, v38
s_nop 0
v_permlane32_swap_b32 v36, v40
v_permlane32_swap_b32 v38, v41
v_max_f32 v36, v36, v40
v_max_f32 v38, v38, v41
v_sub_f32 v32, v32, v36
v_sub_f32 v34, v34, v38
v_mul_f32 v32, s12, v32
v_mul_f32 v34, s12, v34
v_exp_f32 v32, v32
v_exp_f32 v34, v34
v_mul_f32 v37, v32, v33
v_mul_f32 v39, v34, v35
s_nop 0
v_add_f32_dpp v37, v37, v37 row_ror:8 row_mask:0xf bank_mask:0xf
v_add_f32_dpp v39, v39, v39 row_ror:8 row_mask:0xf bank_mask:0xf
s_nop 0
v_add_f32_dpp v37, v37, v37 row_ror:4 row_mask:0xf bank_mask:0xf
v_add_f32_dpp v39, v39, v39 row_ror:4 row_mask:0xf bank_mask:0xf
s_nop 0
v_add_f32_dpp v37, v37, v37 row_ror:2 row_mask:0xf bank_mask:0xf
v_add_f32_dpp v39, v39, v39 row_ror:2 row_mask:0xf bank_mask:0xf
s_nop 0
v_add_f32_dpp v37, v37, v37 row_ror:1 row_mask:0xf bank_mask:0xf
v_add_f32_dpp v39, v39, v39 row_ror:1 row_mask:0xf bank_mask:0xf
v_mov_b32 v40, v37
v_mov_b32 v41, v39
s_nop 0
v_permlane16_swap_b32 v37, v40
v_permlane16_swap_b32 v39, v41
v_add_f32 v37, v37, v40
v_add_f32 v39, v39, v41
v_mov_b32 v40, v37
v_mov_b32 v41, v39
s_nop 0
v_permlane32_swap_b32 v37, v40
v_permlane32_swap_b32 v39, v41
v_add_f32 v37, v37, v40
v_add_f32 v39, v39, v41
v_rcp_f32 v37, v37
v_rcp_f32 v39, v39
v_mov_b32 v30, 156160
v_min_u32 v36, -2, v36
v_min_u32 v37, -2, v37
v_min_u32 v38, -2, v38
v_min_u32 v39, -2, v39
s_mov_b32 exec_lo, 1
s_mov_b32 exec_hi, 0
ds_write_b128 v30, v[36:39]
s_mov_b64 exec, -1
s_lshl_b32 s11, s3, 13
v_lshrrev_b32 v153, 4, v0
v_bfe_u32 v154, v0, 2, 2
v_and_b32 v155, 3, v0
v_lshrrev_b32 v129, 1, v154
v_and_b32 v128, 1, v153
v_lshl_or_b32 v129, v128, 1, v129
v_lshl_add_u32 v127, v153, 3, v154
v_lshlrev_b32 v126, 7, v127
v_lshl_add_u32 v126, v155, 3, v126
v_add_u32 v149, s11, v126
v_lshl_add_u32 v149, v153, 10, v149
v_and_b32 v129, 1, v129
v_xor_b32 v150, 0, v129
v_lshl_add_u32 v124, v150, 5, v149
v_xor_b32 v150, 1, v129
v_lshl_add_u32 v125, v150, 5, v149
v_xor_b32 v150, 2, v129
v_lshl_add_u32 v126, v150, 5, v149
v_xor_b32 v150, 3, v129
v_lshl_add_u32 v151, v150, 5, v149
s_lshl_b32 s11, s3, 12
s_add_u32 s12, s11, 65536
v_lshrrev_b32 v150, 1, v153
v_lshlrev_b32 v150, 4, v150
v_add_u32 v150, v128, v150
v_lshl_add_u32 v150, v154, 1, v150
v_lshlrev_b32 v150, 7, v150
v_lshrrev_b32 v128, 1, v154
v_lshl_add_u32 v150, v155, 3, v150
v_add_u32 v150, s12, v150
v_mov_b32 v127, v151
v_xor_b32 v129, 1, v128
v_lshl_add_u32 v129, v129, 5, v150
v_lshl_add_u32 v128, v128, 5, v150
s_mul_i32 s12, s3, 2112
s_add_u32 s12, s12, 122880
v_and_b32 v150, 31, v0
v_lshlrev_b32 v150, 5, v150
v_lshrrev_b32 v151, 5, v0
v_lshl_add_u32 v150, v151, 4, v150
v_add_u32 v133, s12, v150
s_lshl_b32 s12, s3, 8
v_mul_u32_u24 v134, 2112, v153
v_and_b32 v150, 15, v0
v_lshl_add_u32 v134, v150, 2, v134
s_add_u32 s13, s12, 122880
v_add_u32 v134, s13, v134
v_add_u32 v130, 8448, v134
v_lshl_add_u32 v150, v0, 2, s12
s_lshl_b32 s13, s9, 14
s_add_u32 s13, s13, 188416
s_lshl_b32 s14, s7, 11
s_add_u32 s14, s14, s13
v_add_u32 v135, s14, v150
s_add_u32 s13, s13, s12
v_and_b32 v150, 7, v0
v_lshrrev_b32 v151, 3, v0
v_lshlrev_b32 v152, 11, v154
v_lshl_add_u32 v152, v153, 6, v152
v_lshl_add_u32 v152, v155, 4, v152
v_add_u32 v136, s13, v152
v_add_u32 v131, 8192, v136
s_add_u32 s13, s12, 157184
v_lshlrev_b32 v152, 4, v153
v_add_u32 v137, s13, v152
v_and_b32 v138, 15, v0
v_lshlrev_b32 v138, 4, v138
s_lshl_b32 s13, s6, 3
s_add_u32 s14, s13, s4
s_mul_i32 s14, s14, 1792
s_lshl_b32 s15, s7, 8
s_add_u32 s14, s14, s15
s_add_u32 s14, s14, 131072
v_add_u32 v139, s14, v138
v_add_u32 v138, 157184, v138
s_mul_i32 s13, s13, 1792
s_add_u32 s13, s13, s12
s_add_u32 s13, s13, 131072
v_mul_u32_u24 v140, 1792, v151
v_lshl_add_u32 v140, v150, 4, v140
v_add_u32 v140, s13, v140
v_lshrrev_b32 v152, 5, v0
v_lshlrev_b32 v152, 5, v152
v_lshl_add_u32 v152, v150, 2, v152
v_bfe_u32 v151, v0, 4, 1
v_lshl_add_u32 v152, v151, 1, v152
v_bfe_u32 v151, v0, 3, 1
v_add_u32 v152, v151, v152
v_lshlrev_b32 v141, 2, v152
v_add_u32 v141, s12, v141
v_add_u32 v141, 0x20000, v141
s_lshl_b32 s13, s3, 7
s_add_u32 s13, s13, 156288
v_lshlrev_b32 v142, 1, v152
v_add_u32 v142, s13, v142
v_lshlrev_b32 v152, 4, v153
v_add_u32 v143, s13, v152
s_mul_i32 s13, s3, 144
s_add_u32 s13, s13, 159232
v_add_u32 v144, s13, v152
v_bfe_u32 v145, v0, 1, 3
v_mul_u32_u24 v145, 144, v145
v_and_b32 v146, 1, v0
v_lshl_add_u32 v145, v146, 4, v145
v_lshl_add_u32 v145, v153, 5, v145
v_add_u32 v145, 159232, v145
s_mul_i32 s13, s6, 14
s_lshl_b32 s14, s3, 1
s_add_u32 s14, s14, s13
s_mul_i32 s14, s14, 56
s_add_u32 s14, s14, s10
s_lshl_b32 s14, s14, 7
s_add_u32 s14, s14, 712704
v_lshrrev_b32 v146, 5, v0
v_mul_u32_u24 v146, 7168, v146
v_lshl_add_u32 v146, v155, 4, v146
v_and_b32 v149, 1, v153
v_lshl_add_u32 v146, v149, 6, v146
v_add_u32 v146, s14, v146
s_lshr_b32 s14, s10, 1
s_add_u32 s13, s13, s14
s_mul_i32 s13, s13, 7168
s_and_b32 s14, s10, 1
s_lshl_b32 s14, s14, 6
s_add_u32 s13, s13, s14
s_add_u32 s13, s13, 716800
v_lshrrev_b32 v147, 2, v0
v_lshlrev_b32 v147, 7, v147
v_lshl_add_u32 v147, v155, 4, v147
v_add_u32 v147, s13, v147
v_lshlrev_b32 v148, 2, v155
v_lshrrev_b32 v152, 5, v0
v_lshl_add_u32 v148, v152, 1, v148
v_bfe_u32 v152, v0, 4, 1
v_add_u32 v148, v152, v148
s_lshl_b32 s13, s10, 4
v_add_u32 v148, s13, v148
s_lshl_b32 s13, s3, 4
s_add_u32 s13, s13, 160384
v_lshrrev_b32 v132, 5, v0
v_and_b32 v149, 1, v0
v_lshl_add_u32 v132, v132, 1, v149
v_lshl_add_u32 v132, v132, 2, s13
v_add_u32 v149, 1, v0
v_and_b32 v149, 7, v149
v_lshlrev_b32 v150, 4, v149
v_add_u32 v150, 160368, v150
v_min_u32 v151, 1, v149
v_cvt_f32_u32 v151, v151
v_mul_f32 v151, 0x42800000, v151
s_sub_u32 s13, 94208, s11
v_lshrrev_b32 v152, 1, v154
v_and_b32 v149, 1, v153
v_lshl_or_b32 v152, v149, 1, v152
v_xor_b32 v152, v155, v152
v_lshlrev_b32 v152, 5, v152
v_lshl_add_u32 v149, v153, 3, v154
v_lshl_add_u32 v152, v149, 7, v152
s_add_u32 s13, s11, 94208
v_add_u32 v152, s13, v152
ds_read_b64_tr_b16 v[156:157], v124 offset:0
ds_read_b64_tr_b16 v[158:159], v124 offset:512
ds_read_b64_tr_b16 v[160:161], v125 offset:0
ds_read_b64_tr_b16 v[162:163], v125 offset:512
ds_read_b64_tr_b16 v[164:165], v126 offset:0
ds_read_b64_tr_b16 v[166:167], v126 offset:512
ds_read_b64_tr_b16 v[168:169], v127 offset:0
ds_read_b64_tr_b16 v[170:171], v127 offset:512
ds_read_b64_tr_b16 v[172:173], v126 offset:1024
ds_read_b64_tr_b16 v[174:175], v126 offset:1536
ds_read_b64_tr_b16 v[176:177], v127 offset:1024
ds_read_b64_tr_b16 v[178:179], v127 offset:1536
ds_read_b64_tr_b16 v[180:181], v124 offset:1024
ds_read_b64_tr_b16 v[182:183], v124 offset:1536
ds_read_b64_tr_b16 v[184:185], v125 offset:1024
ds_read_b64_tr_b16 v[186:187], v125 offset:1536
s_waitcnt lgkmcnt(0)
L_tail:
v_mov_b32 v12, 0
v_mov_b32 v13, 0
v_mov_b32 v14, 0
v_mov_b32 v15, 0
L_tail2:
s_waitcnt lgkmcnt(0)
s_barrier
ds_read2_b32 v[8:9], v134 offset1:16
ds_read2_b32 v[10:11], v134 offset0:32 offset1:48
s_mov_b32 exec_hi, 0xffff
ds_read2_b32 v[12:13], v130 offset1:16
ds_read2_b32 v[14:15], v130 offset0:32 offset1:48
s_mov_b32 exec_hi, -1
s_cmp_eq_u32 s68, 1
s_waitcnt lgkmcnt(0)
v_add_f32 v8, v8, v12
v_add_f32 v10, v10, v14
v_add_f32 v9, v9, v13
v_add_f32 v11, v11, v15
v_permlane32_swap_b32 v8, v10
s_nop 0
v_permlane32_swap_b32 v9, v11
v_add_f32 v8, v8, v10
v_add_f32 v9, v9, v11
s_nop 1
v_permlane16_swap_b32 v8, v9
v_add_f32 v8, v8, v9
s_cbranch_scc1 L_o_near
global_store_dword v135, v8, s[40:41] sc1
s_branch L_o_put
L_o_near:
global_store_dword v135, v8, s[40:41]
L_o_put:
s_cmp_eq_u32 s7, 7
s_cbranch_scc1 L_exit
global_load_dwordx4 v[12:15], v136, s[40:41] sc1
global_load_dwordx4 v[16:19], v131, s[40:41] sc1
ds_read_b32 v72, v141 offset:6656
ds_read_b32 v73, v141 offset:8448
ds_read_b32 v74, v141 offset:10240
ds_read_b32 v75, v141 offset:12032
s_branch L_pa_wait
L_pa:
global_load_dwordx4 v[12:15], v136, s[40:41] sc1
global_load_dwordx4 v[16:19], v131, s[40:41] sc1
L_pa_wait:
s_waitcnt vmcnt(0)
v_max3_u32 v20, v12, v13, v14
v_max3_u32 v21, v15, v16, v17
v_max_u32 v22, v18, v19
v_max3_u32 v23, v20, v21, v22
v_cmp_eq_u32 vcc, -1, v23
s_cbranch_vccz L_pa_done
s_mov_b64 exec, vcc
s_sub_u32 s66, s66, 1
s_cbranch_scc0 L_pa
s_mov_b32 s66, 0
L_pa_done:
s_mov_b64 exec, -1
v_pk_add_f32 v[12:13], v[12:13], v[16:17]
v_pk_add_f32 v[14:15], v[14:15], v[18:19]
s_nop 0
v_add_f32_dpp v12, v12, v12 row_ror:4 row_mask:0xf bank_mask:0xf
v_add_f32_dpp v13, v13, v13 row_ror:4 row_mask:0xf bank_mask:0xf
v_add_f32_dpp v14, v14, v14 row_ror:4 row_mask:0xf bank_mask:0xf
v_add_f32_dpp v15, v15, v15 row_ror:4 row_mask:0xf bank_mask:0xf
v_add_f32_dpp v12, v12, v12 row_ror:8 row_mask:0xf bank_mask:0xf
v_add_f32_dpp v13, v13, v13 row_ror:8 row_mask:0xf bank_mask:0xf
v_add_f32_dpp v14, v14, v14 row_ror:8 row_mask:0xf bank_mask:0xf
v_add_f32_dpp v15, v15, v15 row_ror:8 row_mask:0xf bank_mask:0xf
v_cvt_pk_bf16_f32 v20, v12, v13
v_cvt_pk_bf16_f32 v21, v14, v15
s_nop 0
v_mov_b32_dpp v22, v20 quad_perm:[1,1,1,1] row_mask:0xf bank_mask:0xf
v_mov_b32_dpp v23, v21 quad_perm:[1,1,1,1] row_mask:0xf bank_mask:0xf
v_mov_b32_dpp v24, v20 quad_perm:[2,2,2,2] row_mask:0xf bank_mask:0xf
v_mov_b32_dpp v25, v21 quad_perm:[2,2,2,2] row_mask:0xf bank_mask:0xf
v_mov_b32_dpp v26, v20 quad_perm:[3,3,3,3] row_mask:0xf bank_mask:0xf
v_mov_b32_dpp v27, v21 quad_perm:[3,3,3,3] row_mask:0xf bank_mask:0xf
v_mfma_f32_16x16x32_bf16 v[28:31], v[156:159], v[20:23], 0
v_mfma_f32_16x16x32_bf16 v[32:35], v[160:163], v[20:23], 0
v_mfma_f32_16x16x32_bf16 v[36:39], v[164:167], v[20:23], 0
v_mfma_f32_16x16x32_bf16 v[40:43], v[168:171], v[20:23], 0
v_mfma_f32_16x16x32_bf16 v[28:31], v[172:175], v[24:27], v[28:31]
v_mfma_f32_16x16x32_bf16 v[32:35], v[176:179], v[24:27], v[32:35]
v_mfma_f32_16x16x32_bf16 v[36:39], v[180:183], v[24:27], v[36:39]
v_mfma_f32_16x16x32_bf16 v[40:43], v[184:187], v[24:27], v[40:43]
s_mov_b32 exec_lo, 0x00010001
s_mov_b32 exec_hi, 0x00010001
s_nop 2
ds_write_b128 v137, v[28:31] offset:0
ds_write_b128 v137, v[32:35] offset:64
ds_write_b128 v137, v[36:39] offset:128
ds_write_b128 v137, v[40:43] offset:192
s_mov_b64 exec, -1
s_waitcnt lgkmcnt(0)
s_barrier
s_cmp_eq_u32 s3, 7
s_cbranch_scc1 L_w7
s_barrier
L_pb:
global_load_dwordx4 v[12:15], v140, s[40:41] sc1
global_load_dwordx4 v[16:19], v140, s[40:41] offset:128 sc1
s_waitcnt vmcnt(0)
v_max3_u32 v20, v12, v13, v14
v_max3_u32 v21, v15, v16, v17
v_max_u32 v22, v18, v19
v_max3_u32 v23, v20, v21, v22
v_cmp_eq_u32 vcc, -1, v23
s_cbranch_vccz L_pb_done
s_mov_b64 exec, vcc
s_sub_u32 s66, s66, 1
s_cbranch_scc0 L_pb
s_mov_b32 s66, 0
L_pb_done:
s_mov_b64 exec, -1
v_permlane32_swap_b32 v12, v16
v_permlane32_swap_b32 v13, v17
v_permlane32_swap_b32 v14, v18
v_permlane32_swap_b32 v15, v19
v_pk_add_f32 v[12:13], v[12:13], v[16:17]
v_pk_add_f32 v[14:15], v[14:15], v[18:19]
s_nop 1
v_permlane16_swap_b32 v12, v14
v_permlane16_swap_b32 v13, v15
v_pk_add_f32 v[12:13], v[12:13], v[14:15]
s_nop 1
v_add_f32_dpp v16, v12, v12 row_ror:8 row_mask:0xf bank_mask:0x3
s_nop 1
v_add_f32_dpp v16, v13, v13 row_ror:8 row_mask:0xf bank_mask:0xc
v_cvt_pk_bf16_f32 v16, 0, v16
v_mul_f32 v16, v72, v16
v_cvt_pk_bf16_f32 v16, 0, v16
v_add_f32 v16, v73, v16
v_cvt_pk_bf16_f32 v16, 0, v16
s_nop 0
v_readfirstlane_b32 s12, v16
ds_write_b32 v141, v16 offset:15616
s_nop 0
v_subrev_f32 v17, s12, v16
v_mul_f32 v18, v17, v17
s_nop 1
v_permlane32_swap_b32 v17, v18
v_add_f32 v17, v17, v18
s_nop 1
v_add_f32_dpp v17, v17, v17 row_ror:8 row_mask:0xf bank_mask:0xf
s_nop 1
v_add_f32_dpp v17, v17, v17 row_ror:4 row_mask:0xf bank_mask:0xf
s_nop 1
v_add_f32_dpp v17, v17, v17 row_ror:2 row_mask:0xf bank_mask:0xf
s_nop 1
v_add_f32_dpp v17, v17, v17 row_ror:1 row_mask:0xf bank_mask:0xf
v_mov_b32 v18, v17
s_nop 1
v_permlane16_swap_b32 v17, v18
v_add_f32 v17, v17, v18
v_writelane_b32 v17, s12, 1
s_mov_b32 exec_lo, 3
s_mov_b32 exec_hi, 1
ds_write_b32 v132, v17
s_mov_b64 exec, -1
s_waitcnt lgkmcnt(0)
s_barrier
ds_read_b96 v[24:26], v150
s_waitcnt lgkmcnt(0)
v_mov_b32_dpp v27, v25 row_newbcast:0 row_mask:0xf bank_mask:0xf
v_fmac_f32 v25, 0x3c800000, v24
v_mul_f32 v24, v24, v24
v_sub_f32 v38, v25, v27
v_fmac_f32 v26, 0xbc800000, v24
v_mul_f32 v25, v151, v38
v_fmac_f32 v26, v25, v38
s_nop 0
v_add_f32_dpp v25, v25, v25 quad_perm:[1,0,3,2] row_mask:0xf bank_mask:0xf
v_add_f32_dpp v26, v26, v26 quad_perm:[1,0,3,2] row_mask:0xf bank_mask:0xf
s_nop 0
v_add_f32_dpp v25, v25, v25 quad_perm:[2,3,0,1] row_mask:0xf bank_mask:0xf
v_add_f32_dpp v26, v26, v26 quad_perm:[2,3,0,1] row_mask:0xf bank_mask:0xf
s_nop 0
v_add_f32_dpp v25, v25, v25 row_half_mirror row_mask:0xf bank_mask:0xf
v_add_f32_dpp v26, v26, v26 row_half_mirror row_mask:0xf bank_mask:0xf
v_mul_f32 v25, 0x3b124925, v25
v_mul_f32 v41, 0x3b124925, v26
v_add_f32 v38, v25, v27
v_fma_f32 v41, -v25, v25, v41
v_cvt_pk_bf16_f32 v38, 0, v38
v_max_f32 v41, 0, v41
v_sub_f32 v16, v16, v38
v_cvt_pk_bf16_f32 v41, 0, v41
v_cvt_pk_bf16_f32 v16, 0, v16
v_add_f32 v41, 0x3727c5ac, v41
v_cvt_pk_bf16_f32 v41, 0, v41
v_sqrt_f32 v41, v41
s_nop 0
v_cvt_pk_bf16_f32 v41, 0, v41
v_rcp_f32 v41, v41
s_nop 0
v_mul_f32 v16, v16, v41
v_cvt_pk_bf16_f32 v16, 0, v16
v_mul_f32 v16, v16, v74
v_cvt_pk_bf16_f32 v16, 0, v16
v_add_f32 v16, v16, v75
s_nop 1
v_mov_b32_dpp v17, v16 row_shl:1 row_mask:0xf bank_mask:0xf
v_cvt_pk_bf16_f32 v16, v16, v17
s_nop 1
v_mov_b32_dpp v24, v16 row_newbcast:0 row_mask:0xf bank_mask:0xf
v_mov_b32_dpp v25, v16 row_newbcast:2 row_mask:0xf bank_mask:0xf
v_mov_b32_dpp v26, v16 row_newbcast:4 row_mask:0xf bank_mask:0xf
v_mov_b32_dpp v27, v16 row_newbcast:6 row_mask:0xf bank_mask:0xf
v_mov_b32_dpp v28, v16 row_newbcast:8 row_mask:0xf bank_mask:0xf
v_mov_b32_dpp v29, v16 row_newbcast:10 row_mask:0xf bank_mask:0xf
v_mov_b32_dpp v30, v16 row_newbcast:12 row_mask:0xf bank_mask:0xf
v_mov_b32_dpp v31, v16 row_newbcast:14 row_mask:0xf bank_mask:0xf
v_mfma_f32_16x16x32_bf16 v[32:35], v[188:191], v[24:27], 0
v_mfma_f32_16x16x32_bf16 v[36:39], v[192:195], v[24:27], 0
v_mfma_f32_16x16x32_bf16 v[32:35], v[196:199], v[28:31], v[32:35]
v_mfma_f32_16x16x32_bf16 v[36:39], v[200:203], v[28:31], v[36:39]
s_mov_b32 exec_lo, 0x00010001
s_mov_b32 exec_hi, 0x00010001
s_nop 4
ds_write_b128 v144, v[32:35] offset:0
ds_write_b128 v144, v[36:39] offset:64
s_mov_b64 exec, -1
s_waitcnt lgkmcnt(0)
s_barrier
ds_read_b128 v[12:15], v145
s_waitcnt lgkmcnt(0)
v_add_f32_dpp v12, v12, v12 quad_perm:[2,3,0,1] row_mask:0xf bank_mask:0xf
v_add_f32_dpp v13, v13, v13 quad_perm:[2,3,0,1] row_mask:0xf bank_mask:0xf
v_add_f32_dpp v14, v14, v14 quad_perm:[2,3,0,1] row_mask:0xf bank_mask:0xf
v_add_f32_dpp v15, v15, v15 quad_perm:[2,3,0,1] row_mask:0xf bank_mask:0xf
v_add_f32_dpp v12, v12, v12 row_ror:4 row_mask:0xf bank_mask:0xf
v_add_f32_dpp v13, v13, v13 row_ror:4 row_mask:0xf bank_mask:0xf
v_add_f32_dpp v14, v14, v14 row_ror:4 row_mask:0xf bank_mask:0xf
v_add_f32_dpp v15, v15, v15 row_ror:4 row_mask:0xf bank_mask:0xf
v_add_f32_dpp v12, v12, v12 row_ror:8 row_mask:0xf bank_mask:0xf
v_add_f32_dpp v13, v13, v13 row_ror:8 row_mask:0xf bank_mask:0xf
v_add_f32_dpp v14, v14, v14 row_ror:8 row_mask:0xf bank_mask:0xf
v_add_f32_dpp v15, v15, v15 row_ror:8 row_mask:0xf bank_mask:0xf
v_cvt_pk_bf16_f32 v16, v12, v13
v_cvt_pk_bf16_f32 v17, v14, v15
v_pk_max_i16 v16, v16, 0
v_pk_max_i16 v17, v17, 0
s_nop 0
v_mov_b32_dpp v20, v16 quad_perm:[0,0,0,0] row_mask:0xf bank_mask:0xf
v_mov_b32_dpp v21, v17 quad_perm:[0,0,0,0] row_mask:0xf bank_mask:0xf
v_mov_b32_dpp v22, v16 quad_perm:[1,1,1,1] row_mask:0xf bank_mask:0xf
v_mov_b32_dpp v23, v17 quad_perm:[1,1,1,1] row_mask:0xf bank_mask:0xf
s_nop 1
v_mfma_f32_16x16x32_bf16 v[28:31], v[108:111], v[20:23], 0
v_mfma_f32_16x16x32_bf16 v[32:35], v[112:115], v[20:23], 0
v_mfma_f32_16x16x32_bf16 v[36:39], v[116:119], v[20:23], 0
v_mfma_f32_16x16x32_bf16 v[40:43], v[120:123], v[20:23], 0
s_mov_b32 exec_lo, 0x000f000f
s_mov_b32 exec_hi, 0x000f000f
s_nop 3
v_cndmask_b32 v28, v28, v32, s[72:73]
v_cndmask_b32 v29, v29, v33, s[72:73]
v_cndmask_b32 v30, v30, v34, s[72:73]
v_cndmask_b32 v31, v31, v35, s[72:73]
v_cndmask_b32 v36, v36, v40, s[76:77]
v_cndmask_b32 v37, v37, v41, s[76:77]
v_cndmask_b32 v38, v38, v42, s[76:77]
v_cndmask_b32 v39, v39, v43, s[76:77]
s_or_b64 vcc, s[74:75], s[76:77]
v_cndmask_b32 v28, v28, v36, vcc
v_cndmask_b32 v29, v29, v37, vcc
v_cndmask_b32 v30, v30, v38, vcc
v_cndmask_b32 v31, v31, v39, vcc
global_store_dwordx4 v146, v[28:31], s[40:41] sc1
s_waitcnt vmcnt(0)
s_barrier
s_branch L_exit
L_w7:
s_mov_b32 exec_lo, 0xffff
s_mov_b32 exec_hi, 0
ds_read_b128 v[8:11], v138 offset:0
ds_read_b128 v[12:15], v138 offset:256
ds_read_b128 v[16:19], v138 offset:512
ds_read_b128 v[20:23], v138 offset:768
ds_read_b128 v[24:27], v138 offset:1024
ds_read_b128 v[28:31], v138 offset:1280
ds_read_b128 v[32:35], v138 offset:1536
ds_read_b128 v[36:39], v138 offset:1792
s_waitcnt lgkmcnt(6)
v_pk_add_f32 v[8:9], v[8:9], v[12:13]
v_pk_add_f32 v[10:11], v[10:11], v[14:15]
s_waitcnt lgkmcnt(4)
v_pk_add_f32 v[16:17], v[16:17], v[20:21]
v_pk_add_f32 v[18:19], v[18:19], v[22:23]
v_pk_add_f32 v[8:9], v[8:9], v[16:17]
v_pk_add_f32 v[10:11], v[10:11], v[18:19]
s_waitcnt lgkmcnt(2)
v_pk_add_f32 v[24:25], v[24:25], v[28:29]
v_pk_add_f32 v[26:27], v[26:27], v[30:31]
s_waitcnt lgkmcnt(0)
v_pk_add_f32 v[32:33], v[32:33], v[36:37]
v_pk_add_f32 v[34:35], v[34:35], v[38:39]
v_pk_add_f32 v[24:25], v[24:25], v[32:33]
v_pk_add_f32 v[26:27], v[26:27], v[34:35]
v_pk_add_f32 v[8:9], v[8:9], v[24:25]
v_pk_add_f32 v[10:11], v[10:11], v[26:27]
global_store_dwordx4 v139, v[8:11], s[40:41] sc1
s_waitcnt vmcnt(0)
s_barrier
s_mov_b64 exec, -1
s_cmp_ge_u32 s10, 28
s_cbranch_scc1 L_exit
v_lshlrev_b32 v40, 2, v148
v_add_u32 v40, 0x20000, v40
s_mul_i32 s12, s6, 448
v_add_u32 v148, s12, v148
v_lshlrev_b32 v148, 1, v148
v_mov_b32 v24, 0
v_mov_b32 v25, 0
v_mov_b32 v26, 0
v_mov_b32 v27, 0
s_barrier
ds_read_b32 v41, v40 offset:15616
ds_read_b32 v42, v40 offset:13824
s_barrier
s_barrier
L_pc:
global_load_dwordx4 v[12:15], v147, s[40:41] offset:-4096 sc1
global_load_dwordx4 v[16:19], v147, s[40:41] offset:-2048 sc1
global_load_dwordx4 v[20:23], v147, s[40:41] offset:0 sc1
s_mov_b32 s13, exec_hi
s_mov_b32 exec_hi, 0
s_cbranch_execz L_pc_s
global_load_dwordx4 v[24:27], v147, s[40:41] offset:2048 sc1
L_pc_s:
s_mov_b32 exec_hi, s13
s_waitcnt vmcnt(0)
v_max3_u32 v28, v12, v13, v14
v_max3_u32 v29, v15, v16, v17
v_max3_u32 v30, v18, v19, v20
v_max3_u32 v31, v21, v22, v23
v_max3_u32 v32, v24, v25, v26
v_max3_u32 v28, v28, v29, v30
v_max3_u32 v29, v31, v32, v27
v_max_u32 v30, v28, v29
v_cmp_eq_u32 vcc, -1, v30
s_cbranch_vccz L_pc_done
s_mov_b64 exec, vcc
s_sub_u32 s66, s66, 1
s_cbranch_scc0 L_pc
s_mov_b32 s66, 0
L_pc_done:
s_mov_b64 exec, -1
v_pk_add_f32 v[12:13], v[12:13], v[16:17]
v_pk_add_f32 v[20:21], v[20:21], v[24:25]
v_pk_add_f32 v[14:15], v[14:15], v[18:19]
v_pk_add_f32 v[22:23], v[22:23], v[26:27]
v_pk_add_f32 v[12:13], v[12:13], v[20:21]
v_pk_add_f32 v[14:15], v[14:15], v[22:23]
s_nop 1
v_permlane32_swap_b32 v12, v14
v_permlane32_swap_b32 v13, v15
v_add_f32 v12, v12, v14
v_add_f32 v13, v13, v15
s_nop 1
v_permlane16_swap_b32 v12, v13
v_add_f32 v12, v12, v13
s_nop 1
v_add_f32_dpp v12, v12, v12 row_ror:8 row_mask:0xf bank_mask:0xf
s_nop 1
v_add_f32_dpp v12, v12, v12 row_ror:4 row_mask:0xf bank_mask:0xf
s_waitcnt lgkmcnt(0)
v_cvt_pk_bf16_f32 v12, 0, v12
v_mul_f32 v12, v42, v12
v_cvt_pk_bf16_f32 v12, 0, v12
v_add_f32 v12, v41, v12
v_cvt_pk_bf16_f32 v12, v12, v12
s_mov_b32 exec_lo, 0x000f000f
s_mov_b32 exec_hi, 0x000f000f
global_store_short v148, v12, s[36:37]
L_exit:
L_end:
s_endpgm
L_code_end:
.section .rodata,"a"
.p2align 6
.amdhsa_kernel adaLN_cond__gqa_block_cached__dense_activation_relu__decode_kernel
  .amdhsa_next_free_vgpr 256
  .amdhsa_next_free_sgpr 100
  .amdhsa_accum_offset 256
  .amdhsa_group_segment_fixed_size 0
  .amdhsa_kernarg_size 104
  .amdhsa_user_sgpr_count 2
  .amdhsa_user_sgpr_kernarg_segment_ptr 1
  .amdhsa_system_sgpr_workgroup_id_x 1
  .amdhsa_float_denorm_mode_32 3
.end_amdhsa_kernel
```
